```python
import torch

def _softmax(x, axis=-1):
    return torch.softmax(x, dim=axis)
def _gelu(x):
    return torch.nn.functional.gelu(x, approximate="tanh")
def _silu(x):
    return torch.nn.functional.silu(x)
def _sigmoid(x):
    return torch.sigmoid(x)
def _layernorm(x, axis=-1, eps=1e-5):
    m = x.mean(dim=axis, keepdim=True)
    v = x.var(dim=axis, keepdim=True, unbiased=False)
    return (x - m) / torch.sqrt(v + eps)
def _scatter_add(tgt, idx, src, axis=0):
    return tgt.clone().index_add_(axis, idx, src)
def _segment_sum(src, seg, n):
    out = torch.zeros((n,) + src.shape[1:], dtype=src.dtype)
    return out.index_add_(0, seg, src)
def _pad(x, pw):
    flat = tuple(v for pair in reversed(pw) for v in pair)
    return torch.nn.functional.pad(x, flat)

kernel_name = 'recurrent_scan__sliding_block_cached__glu_gated_glu__decode'

def setup_inputs():

    _w = (lambda a: (lambda t: t.to(torch.bfloat16) if t.is_floating_point() else t)(torch.as_tensor(a)))
    def _A_setup():
        B, Sq, D = 2, 1, 512
        Hq, Hkv, Sk, Dh = 32, 8, 32768, 128
        assert Hq % Hkv == 0, (Hq, Hkv)
        return {
            "x": _w((lambda *s: torch.randn(*s, dtype=torch.bfloat16) * 0.05)(B, Sq, D)),
            "k_cache": _w((lambda *s: torch.randn(*s, dtype=torch.bfloat16) * 1.6)(B, Hkv, Sk, Dh)),
            "v_cache": _w((lambda *s: torch.randn(*s, dtype=torch.bfloat16) * 0.2)(B, Hkv, Sk, Dh)),
            "wq": _w((lambda *s: torch.randn(*s, dtype=torch.bfloat16) * 1.6)(D, Hq * Dh) * (D ** -0.5)),
            "wo": _w((lambda *s: torch.randn(*s, dtype=torch.bfloat16) * 0.2)(Hq * Dh, D) * ((Hq * Dh) ** -0.5)),
        }
    _A_in = _A_setup()

    def _B_setup():
        B, S, D, F = 2, 1, 512, 1792
        return {
            "x": _w((lambda *s: torch.randn(*s, dtype=torch.bfloat16) * 0.05)(B, S, D)),
            "w_gate": _w((lambda *s: torch.randn(*s, dtype=torch.bfloat16) * 1.6)(D, F)),
            "w_up": _w((lambda *s: torch.randn(*s, dtype=torch.bfloat16) * 0.1)(D, F)),
            "w_down": _w((lambda *s: torch.randn(*s, dtype=torch.bfloat16) * 0.1)(F, D)),
        }
    _B_in = _B_setup()

    return {
        "A_x": _A_in["x"],
        "A_k_cache": _A_in["k_cache"],
        "A_v_cache": _A_in["v_cache"],
        "A_wq": _A_in["wq"],
        "A_wo": _A_in["wo"],
        "B_x": _B_in["x"],
        "B_w_gate": _B_in["w_gate"],
        "B_w_up": _B_in["w_up"],
        "B_w_down": _B_in["w_down"],
    }

def reference(A_x, A_k_cache, A_v_cache, A_wq, A_wo, B_x, B_w_gate, B_w_up, B_w_down):
    def _A_ref(x, k_cache, v_cache, wq, wo):
        B, Sq, D = x.shape
        Hq, Dh = 32, 128
        Hkv, Sk = k_cache.shape[1], k_cache.shape[2]
        W = min(4096, max(256, Sk // 4))
        rep = Hq // Hkv
        q = (lambda x, *d: x.permute(*d))((x @ wq).reshape(B, Sq, Hq, Dh), 0, 2, 1, 3)
        k = (lambda x, n, axis: torch.repeat_interleave(x, n, dim=axis))(k_cache[:, :, Sk - W:, :], rep, axis=1)
        v = (lambda x, n, axis: torch.repeat_interleave(x, n, dim=axis))(v_cache[:, :, Sk - W:, :], rep, axis=1)
        scores = torch.einsum("bhqd,bhkd->bhqk", q, k) * (Dh ** -0.5)
        p = _softmax(scores, axis=-1)
        o = torch.einsum("bhqk,bhkd->bhqd", p, v)
        return (lambda x, *d: x.permute(*d))(o, 0, 2, 1, 3).reshape(B, Sq, Hq * Dh) @ wo

    def _B_ref(x, w_gate, w_up, w_down):
        g = torch.einsum("bsd,df->bsf", x, w_gate)
        u = torch.einsum("bsd,df->bsf", x, w_up)
        h = _sigmoid(g) * u
        return torch.einsum("bsf,fd->bsd", h, w_down)

    x = A_x
    xn = _layernorm(x, axis=-1)
    s = _A_ref(xn, A_k_cache, A_v_cache, A_wq, A_wo)
    g = _silu(_B_ref(xn, B_w_gate, B_w_up, B_w_down))
    return x + s * g
```

```asm
; @launch grid=(256,1,1) block=(640,1,1) lds=163840
.amdgcn_target "amdgcn-amd-amdhsa--gfx950"
.text
.globl recurrent_scan__sliding_block_cached__glu_gated_glu__decode_kernel
.p2align 8
.type recurrent_scan__sliding_block_cached__glu_gated_glu__decode_kernel,@function
recurrent_scan__sliding_block_cached__glu_gated_glu__decode_kernel:
    s_load_dwordx16 s[4:19], s[0:1], 0
    s_load_dwordx8 s[20:27], s[0:1], 64
    s_cmp_ge_u32 s2, 256
    s_cbranch_scc1 L_end
    v_lshrrev_b32 v1, 6, v0
    v_and_b32 v0, 63, v0
    s_and_b32 s28, s2, 7
    v_readfirstlane_b32 s30, v1
    s_lshr_b32 s29, s2, 3
    s_and_b32 s31, s29, 1
    s_lshr_b32 s32, s29, 1
    s_mov_b32 s67, 0x200000
    s_cmp_lg_u32 s30, 0
    s_cbranch_scc1 L_notloader
    s_setprio 3
    s_getpc_b64 s[34:35]
L_pcref0:
    v_lshlrev_b32 v22, 7, v0
    v_mov_b32 v25, s35
    v_min_u32 v23, L_codeend-L_pcref0-4, v22
    v_add_u32 v22, 0x2000, v22
    v_add_co_u32 v24, vcc, s34, v23
    s_nop 1
    v_addc_co_u32 v25, vcc, 0, v25, vcc
    v_min_u32 v22, L_codeend-L_pcref0-4, v22
    global_load_dword v26, v[24:25], off
    v_mov_b32 v23, s35
    v_add_co_u32 v22, vcc, s34, v22
    s_nop 1
    v_addc_co_u32 v23, vcc, 0, v23, vcc
    global_load_dword v27, v[22:23], off
    v_lshrrev_b32 v18, 4, v0
    v_lshlrev_b32 v19, 1, v18
    v_and_b32 v20, 7, v0
    v_xor_b32 v20, v19, v20
    v_lshlrev_b32 v20, 4, v20
    v_lshrrev_b32 v21, 3, v0
    v_lshl_add_u32 v2, v21, 13, v20
    s_lshr_b32 s33, s29, 3
    s_lshl_b32 s33, s33, 20
    s_lshl_b32 s34, s28, 10
    s_add_u32 s33, s33, s34
    s_and_b32 s34, s29, 7
    s_lshl_b32 s71, s34, 7
    s_add_u32 s33, s33, s71
    s_mov_b32 s68, 0
    s_mov_b32 m0, 0
    s_mov_b32 s69, -32
    v_mov_b32 v16, 0x26000
    s_waitcnt lgkmcnt(0)
    s_add_u32 s36, s10, s33
    s_addc_u32 s37, s11, 0
    s_mov_b32 s38, 1040512
    s_mov_b32 s39, 0x20000
L_ldq1:
    buffer_load_dwordx4 v2, s[36:39], s68 offen offset:0 nt lds
    s_add_u32 s68, s68, 64512
    s_waitcnt vmcnt(32)
    buffer_load_dwordx4 v2, s[36:39], s68 offen offset:1024 nt lds
    s_add_u32 s68, s68, 64512
    s_waitcnt vmcnt(32)
    buffer_load_dwordx4 v2, s[36:39], s68 offen offset:2048 nt lds
    s_add_u32 s68, s68, 64512
    s_waitcnt vmcnt(32)
    buffer_load_dwordx4 v2, s[36:39], s68 offen offset:3072 nt lds
    s_add_u32 s68, s68, 64512
    s_waitcnt vmcnt(32)
    s_add_u32 s69, s69, 4
    s_mov_b64 exec, 1
    v_mov_b32 v17, s69
    ds_write_b32 v16, v17 offset:7168
    s_mov_b64 exec, -1
    s_add_u32 s68, s68, 4096
    s_add_u32 m0, m0, 4096
    s_cmp_lg_u32 s68, 1048576
    s_cbranch_scc1 L_ldq1
    s_movk_i32 s33, 3584
    v_mad_u32_u24 v3, v21, s33, v20
    s_min_u32 s33, s28, 4
    s_mul_i32 s34, s28, 3
    s_add_u32 s34, s34, s33
    s_lshr_b32 s33, s29, 3
    s_add_u32 s34, s34, s33
    s_and_b32 s35, s29, 7
    s_cmp_lt_u32 s28, 4
    s_cselect_b32 s33, 32, 24
    s_cmp_lt_u32 s29, s33
    s_cselect_b32 s72, -1, 0
    s_mul_i32 s33, s35, 229376
    s_lshl_b32 s70, s34, 7
    s_add_u32 s33, s33, s70
    s_and_b32 s33, s33, s72
    s_add_u32 s40, s16, s33
    s_addc_u32 s41, s17, 0
    s_mov_b32 s42, 225920
    s_mov_b32 s43, 0x20000
    s_and_b32 s42, s42, s72
    s_add_u32 s44, s18, s33
    s_addc_u32 s45, s19, 0
    s_mov_b32 s46, 225920
    s_mov_b32 s47, 0x20000
    s_and_b32 s46, s46, s72
    s_mov_b32 s68, 0
L_ldg2:
    buffer_load_dwordx4 v3, s[40:43], s68 offen offset:0 nt lds
    s_add_u32 s68, s68, 27648
    s_waitcnt vmcnt(32)
    buffer_load_dwordx4 v3, s[40:43], s68 offen offset:1024 nt lds
    s_add_u32 s68, s68, 27648
    s_waitcnt vmcnt(32)
    buffer_load_dwordx4 v3, s[40:43], s68 offen offset:2048 nt lds
    s_add_u32 s68, s68, 27648
    s_waitcnt vmcnt(32)
    buffer_load_dwordx4 v3, s[40:43], s68 offen offset:3072 nt lds
    s_add_u32 s68, s68, 27648
    s_waitcnt vmcnt(32)
    s_add_u32 s69, s69, 4
    s_mov_b64 exec, 1
    v_mov_b32 v17, s69
    ds_write_b32 v16, v17 offset:7168
    s_mov_b64 exec, -1
    s_add_u32 s68, s68, 4096
    s_add_u32 m0, m0, 4096
    s_cmp_lg_u32 s68, 229376
    s_cbranch_scc1 L_ldg2
    s_mov_b32 s68, 0
L_ldu3:
    buffer_load_dwordx4 v3, s[44:47], s68 offen offset:0 nt lds
    s_add_u32 s68, s68, 27648
    s_waitcnt vmcnt(32)
    buffer_load_dwordx4 v3, s[44:47], s68 offen offset:1024 nt lds
    s_add_u32 s68, s68, 27648
    s_waitcnt vmcnt(32)
    buffer_load_dwordx4 v3, s[44:47], s68 offen offset:2048 nt lds
    s_add_u32 s68, s68, 27648
    s_waitcnt vmcnt(32)
    buffer_load_dwordx4 v3, s[44:47], s68 offen offset:3072 nt lds
    s_add_u32 s68, s68, 27648
    s_waitcnt vmcnt(32)
    s_add_u32 s69, s69, 4
    s_mov_b64 exec, 1
    v_mov_b32 v17, s69
    ds_write_b32 v16, v17 offset:7168
    s_mov_b64 exec, -1
    s_add_u32 s68, s68, 4096
    s_add_u32 m0, m0, 4096
    s_cmp_lg_u32 s68, 229376
    s_cbranch_scc1 L_ldu3
    v_lshl_add_u32 v10, v21, 10, v20
    s_lshl_b32 s33, s34, 16
    s_add_u32 s35, s35, 5
    s_and_b32 s35, s35, 7
    s_lshl_b32 s35, s35, 7
    s_add_u32 s33, s33, s35
    s_and_b32 s33, s33, s72
    s_add_u32 s60, s20, s33
    s_addc_u32 s61, s21, 0
    s_mov_b32 s62, 64640
    s_mov_b32 s63, 0x20000
    s_and_b32 s62, s62, s72
    s_lshl_b32 s33, s31, 3
    s_add_u32 s33, s33, s28
    s_lshl_b32 s33, s33, 23
    s_lshl_b32 s34, s32, 16
    s_add_u32 s33, s33, s34
    s_add_u32 s33, s33, 7340032
    s_add_u32 s48, s6, s33
    s_addc_u32 s49, s7, 0
    s_mov_b32 s50, 65536
    s_mov_b32 s51, 0x20000
    s_add_u32 s52, s8, s33
    s_addc_u32 s53, s9, 0
    s_mov_b32 s54, 65536
    s_mov_b32 s55, 0x20000
    v_and_b32 v19, 15, v0
    v_xor_b32 v20, v18, v19
    v_lshlrev_b32 v20, 4, v20
    v_lshl_add_u32 v4, v18, 8, v20
    v_xor_b32 v5, 0x40, v4
    v_xor_b32 v6, 0x80, v4
    v_xor_b32 v7, 0xc0, v4
    v_lshlrev_b32 v20, 1, v18
    v_xor_b32 v20, v20, v19
    v_lshlrev_b32 v20, 4, v20
    v_lshl_add_u32 v8, v18, 8, v20
    v_xor_b32 v9, 0x80, v8
    s_lshl_b32 s33, s28, 2
    s_lshr_b32 s34, s29, 3
    s_add_u32 s33, s33, s34
    s_lshl_b32 s33, s33, 17
    s_add_u32 s71, s29, 3
    s_and_b32 s71, s71, 7
    s_lshl_b32 s71, s71, 7
    s_add_u32 s33, s33, s71
    s_add_u32 s56, s12, s33
    s_addc_u32 s57, s13, 0
    s_mov_b32 s58, 130176
    s_mov_b32 s59, 0x20000
    s_mul_i32 s73, s32, 9
    s_mul_i32 s33, s31, 4
    s_add_u32 s73, s73, s33
    s_mul_i32 s33, s28, 2
    s_add_u32 s73, s73, s33
    s_lshl_b32 s73, s73, 12
    s_and_b32 s73, s73, 0xffff
    s_barrier
    s_add_u32 s69, s69, 8
    s_mov_b32 s68, s73
L_ldk5:
    buffer_load_dwordx4 v4, s[48:51], s68 offen offset:0 nt lds
    s_waitcnt vmcnt(24)
    buffer_load_dwordx4 v5, s[48:51], s68 offen offset:1024 nt lds
    s_waitcnt vmcnt(24)
    buffer_load_dwordx4 v6, s[48:51], s68 offen offset:2048 nt lds
    s_waitcnt vmcnt(24)
    buffer_load_dwordx4 v7, s[48:51], s68 offen offset:3072 nt lds
    s_waitcnt vmcnt(24)
    s_add_u32 s69, s69, 4
    s_mov_b64 exec, 1
    v_mov_b32 v17, s69
    ds_write_b32 v16, v17 offset:7168
    s_mov_b64 exec, -1
    s_add_u32 s68, s68, 4096
    s_and_b32 s68, s68, 0xffff
    s_add_u32 m0, m0, 4096
    s_cmp_lg_u32 m0, 98304
    s_cbranch_scc1 L_ldk5
    s_mov_b32 s68, s73
L_ldv6:
    buffer_load_dwordx4 v8, s[52:55], s68 offen offset:0 nt lds
    s_waitcnt vmcnt(24)
    buffer_load_dwordx4 v9, s[52:55], s68 offen offset:1024 nt lds
    s_waitcnt vmcnt(24)
    buffer_load_dwordx4 v8, s[52:55], s68 offen offset:2048 nt lds
    s_waitcnt vmcnt(24)
    buffer_load_dwordx4 v9, s[52:55], s68 offen offset:3072 nt lds
    s_waitcnt vmcnt(24)
    s_add_u32 s69, s69, 4
    s_mov_b64 exec, 1
    v_mov_b32 v17, s69
    ds_write_b32 v16, v17 offset:7168
    s_mov_b64 exec, -1
    s_add_u32 s68, s68, 4096
    s_and_b32 s68, s68, 0xffff
    s_add_u32 m0, m0, 4096
    s_cmp_lg_u32 m0, 155648
    s_cbranch_scc1 L_ldv6
L_w7:
    s_sub_u32 s67, s67, 1
    s_cbranch_scc1 L_abort
    ds_read_b32 v22, v16 offset:7180
    s_waitcnt lgkmcnt(0)
    v_cmp_le_i32 vcc, 1, v22
    s_cbranch_vccz L_w7
    s_mov_b32 m0, 24576
L_ldt8:
    s_nop 0
    buffer_load_dwordx4 v8, s[52:55], s68 offen offset:0 nt lds
    s_waitcnt vmcnt(24)
    buffer_load_dwordx4 v9, s[52:55], s68 offen offset:1024 nt lds
    s_waitcnt vmcnt(24)
    buffer_load_dwordx4 v8, s[52:55], s68 offen offset:2048 nt lds
    s_waitcnt vmcnt(24)
    buffer_load_dwordx4 v9, s[52:55], s68 offen offset:3072 nt lds
    s_waitcnt vmcnt(24)
    s_add_u32 s69, s69, 4
    s_mov_b64 exec, 1
    v_mov_b32 v17, s69
    ds_write_b32 v16, v17 offset:7168
    s_mov_b64 exec, -1
    s_add_u32 s68, s68, 4096
    s_and_b32 s68, s68, 0xffff
    s_add_u32 m0, m0, 4096
    s_cmp_lg_u32 m0, 32768
    s_cbranch_scc1 L_ldt8
    s_mov_b32 s68, 0
    s_mov_b32 m0, 16384
L_ldd9:
    s_nop 0
    buffer_load_dwordx4 v10, s[60:63], s68 offen offset:0 nt lds
    s_add_u32 s68, s68, 7168
    s_waitcnt vmcnt(24)
    buffer_load_dwordx4 v10, s[60:63], s68 offen offset:1024 nt lds
    s_add_u32 s68, s68, 7168
    s_waitcnt vmcnt(24)
    buffer_load_dwordx4 v10, s[60:63], s68 offen offset:2048 nt lds
    s_add_u32 s68, s68, 7168
    s_waitcnt vmcnt(24)
    buffer_load_dwordx4 v10, s[60:63], s68 offen offset:3072 nt lds
    s_add_u32 s68, s68, 7168
    s_waitcnt vmcnt(24)
    s_add_u32 s69, s69, 4
    s_mov_b64 exec, 1
    v_mov_b32 v17, s69
    ds_write_b32 v16, v17 offset:7168
    s_mov_b64 exec, -1
    s_add_u32 s68, s68, 4096
    s_add_u32 m0, m0, 4096
    s_cmp_lg_u32 s68, 65536
    s_cbranch_scc1 L_ldd9
L_w10:
    s_sub_u32 s67, s67, 1
    s_cbranch_scc1 L_abort
    ds_read_b32 v22, v16 offset:7176
    s_waitcnt lgkmcnt(0)
    v_cmp_le_i32 vcc, 4, v22
    s_cbranch_vccz L_w10
    s_mov_b32 s68, 0
    s_mov_b32 m0, 0
L_ldo11:
    s_nop 0
    buffer_load_dwordx4 v10, s[56:59], s68 offen offset:0 nt lds
    s_add_u32 s68, s68, 7168
    s_waitcnt vmcnt(24)
    buffer_load_dwordx4 v10, s[56:59], s68 offen offset:1024 nt lds
    s_add_u32 s68, s68, 7168
    s_waitcnt vmcnt(24)
    buffer_load_dwordx4 v10, s[56:59], s68 offen offset:2048 nt lds
    s_add_u32 s68, s68, 7168
    s_waitcnt vmcnt(24)
    buffer_load_dwordx4 v10, s[56:59], s68 offen offset:3072 nt lds
    s_add_u32 s68, s68, 7168
    s_waitcnt vmcnt(24)
    s_add_u32 s69, s69, 4
    s_mov_b64 exec, 1
    v_mov_b32 v17, s69
    ds_write_b32 v16, v17 offset:7168
    s_mov_b64 exec, -1
    s_add_u32 s68, s68, 4096
    s_add_u32 m0, m0, 4096
    s_cmp_lg_u32 s68, 65536
    s_cbranch_scc1 L_ldo11
L_ldp12:
    buffer_load_dwordx4 v10, s[56:59], s68 offen offset:0 nt lds
    s_add_u32 s68, s68, 7168
    s_waitcnt vmcnt(24)
    buffer_load_dwordx4 v10, s[56:59], s68 offen offset:1024 nt lds
    s_add_u32 s68, s68, 7168
    s_waitcnt vmcnt(24)
    buffer_load_dwordx4 v10, s[56:59], s68 offen offset:2048 nt lds
    s_add_u32 s68, s68, 7168
    s_waitcnt vmcnt(24)
    buffer_load_dwordx4 v10, s[56:59], s68 offen offset:3072 nt lds
    s_add_u32 s68, s68, 7168
    s_waitcnt vmcnt(24)
    s_add_u32 s69, s69, 4
    s_mov_b64 exec, 1
    v_mov_b32 v17, s69
    ds_write_b32 v16, v17 offset:7168
    s_mov_b64 exec, -1
    s_add_u32 s68, s68, 4096
    s_add_u32 m0, m0, 4096
    s_cmp_lg_u32 s68, 131072
    s_cbranch_scc1 L_ldp12
    s_mov_b64 exec, 1
    v_mov_b32 v17, 164
    s_waitcnt vmcnt(20)
    ds_write_b32 v16, v17 offset:7168
    v_mov_b32 v17, 168
    s_waitcnt vmcnt(16)
    ds_write_b32 v16, v17 offset:7168
    v_mov_b32 v17, 172
    s_waitcnt vmcnt(12)
    ds_write_b32 v16, v17 offset:7168
    v_mov_b32 v17, 176
    s_waitcnt vmcnt(8)
    ds_write_b32 v16, v17 offset:7168
    v_mov_b32 v17, 180
    s_waitcnt vmcnt(4)
    ds_write_b32 v16, v17 offset:7168
    v_mov_b32 v17, 184
    s_waitcnt vmcnt(0)
    ds_write_b32 v16, v17 offset:7168
    s_endpgm
L_cls4:
L_notloader:
    s_cmp_lg_u32 s30, 1
    s_cbranch_scc1 L_cwave
    s_getreg_b32 s70, hwreg(HW_REG_XCC_ID, 0, 4)
    v_mov_b32 v2, 0x26000
    v_lshl_add_u32 v1, v0, 2, v2
    v_mov_b32 v4, 0
    ds_write_b32 v1, v4 offset:7168
    s_add_u32 s70, s70, 1
    v_mov_b32 v56, s70
    v_lshlrev_b32 v12, 5, v0
    v_bfe_u32 v13, v0, 3, 1
    v_bfe_u32 v14, v0, 4, 1
    v_lshl_add_u32 v13, v13, 1, v14
    s_lshl_b32 s33, s28, 7
    s_lshr_b32 s34, s29, 3
    s_lshl_b32 s34, s34, 5
    s_add_u32 s33, s33, s34
    s_and_b32 s34, s29, 3
    s_lshl_b32 s34, s34, 3
    s_add_u32 s33, s33, s34
    s_bfe_u32 s34, s29, 0x10002
    s_lshl_b32 s34, s34, 10
    s_add_u32 s33, s33, s34
    v_lshl_add_u32 v62, v13, 1, s33
    v_mov_b32 v60, 1
    s_movk_i32 s65, 0x3ff
    s_mov_b32 s63, 0xffff0000
    s_lshl_b32 s71, s28, 5
    s_add_u32 s72, s71, s29
    v_and_b32 v57, 31, v0
    s_waitcnt lgkmcnt(0)
    s_mov_b32 s48, s24
    s_mov_b32 s49, s25
    s_mov_b32 s50, 256
    s_mov_b32 s51, 0x20000
    s_mov_b32 s36, s4
    s_mov_b32 s37, s5
    s_mov_b32 s38, 2048
    s_mov_b32 s39, 0x20000
    s_mov_b64 exec, 1
    buffer_store_byte v56, off, s[48:51], s72
    s_mov_b64 exec, -1
    s_mov_b32 s40, s26
    s_mov_b32 s41, s27
    s_mov_b32 s42, 2097152
    s_mov_b32 s43, 0x20000
    buffer_load_dwordx4 v[4:7], v12, s[36:39], 0 offen
    buffer_load_dwordx4 v[8:11], v12, s[36:39], 0 offen offset:16
    buffer_load_dword v3, off, s[40:43], 0 sc1
    buffer_load_ushort v61, v62, s[36:39], 0 offen
    s_mov_b32 s44, s22
    s_mov_b32 s45, s23
    s_mov_b32 s46, 2048
    s_mov_b32 s47, 0x20000
    s_barrier
    v_lshrrev_b32 v13, 5, v0
    v_mul_u32_u24 v13, 1088, v13
    v_bfe_u32 v14, v0, 1, 4
    v_lshl_add_u32 v13, v14, 6, v13
    v_and_b32 v14, 1, v0
    v_lshl_add_u32 v13, v14, 3, v13
    v_add_u32 v13, v2, v13
    s_waitcnt vmcnt(0)
    buffer_load_ubyte v58, v57, s[48:51], s71 offen sc1
    v_lshlrev_b32 v16, 16, v4
    v_and_b32 v17, s63, v4
    v_lshlrev_b32 v18, 16, v5
    v_and_b32 v19, s63, v5
    v_lshlrev_b32 v20, 16, v6
    v_and_b32 v21, s63, v6
    v_lshlrev_b32 v22, 16, v7
    v_and_b32 v23, s63, v7
    v_lshlrev_b32 v24, 16, v8
    v_and_b32 v25, s63, v8
    v_lshlrev_b32 v26, 16, v9
    v_and_b32 v27, s63, v9
    v_lshlrev_b32 v28, 16, v10
    v_and_b32 v29, s63, v10
    v_lshlrev_b32 v30, 16, v11
    v_and_b32 v31, s63, v11
    v_add_u32 v3, 1, v3
    v_add_f32 v4, v16, v20
    v_add_f32 v5, v17, v21
    v_add_f32 v6, v18, v22
    v_add_f32 v7, v19, v23
    v_add_f32 v4, v4, v24
    v_add_f32 v5, v5, v25
    v_add_f32 v6, v6, v26
    v_add_f32 v7, v7, v27
    v_add_f32 v4, v4, v28
    v_add_f32 v5, v5, v29
    v_add_f32 v6, v6, v30
    v_add_f32 v7, v7, v31
    v_add_f32 v4, v4, v5
    v_add_f32 v6, v6, v7
    v_add_f32 v4, v4, v6
    s_nop 1
    v_add_f32_dpp v4, v4, v4 row_ror:8 row_mask:0xf bank_mask:0xf
    s_nop 1
    v_add_f32_dpp v4, v4, v4 row_ror:4 row_mask:0xf bank_mask:0xf
    s_nop 1
    v_add_f32_dpp v4, v4, v4 row_ror:2 row_mask:0xf bank_mask:0xf
    s_nop 1
    v_add_f32_dpp v4, v4, v4 row_ror:1 row_mask:0xf bank_mask:0xf
    v_mov_b32 v5, v4
    s_nop 1
    v_permlane16_swap_b32 v4, v5
    v_add_f32 v4, v4, v5
    v_mul_f32 v4, 0x3b000000, v4
    v_sub_f32 v32, v16, v4
    v_sub_f32 v33, v17, v4
    v_sub_f32 v34, v18, v4
    v_sub_f32 v35, v19, v4
    v_sub_f32 v36, v20, v4
    v_sub_f32 v37, v21, v4
    v_sub_f32 v38, v22, v4
    v_sub_f32 v39, v23, v4
    v_sub_f32 v40, v24, v4
    v_sub_f32 v41, v25, v4
    v_sub_f32 v42, v26, v4
    v_sub_f32 v43, v27, v4
    v_sub_f32 v44, v28, v4
    v_sub_f32 v45, v29, v4
    v_sub_f32 v46, v30, v4
    v_sub_f32 v47, v31, v4
    v_mul_f32 v5, v32, v32
    v_mul_f32 v6, v33, v33
    v_fmac_f32 v5, v34, v34
    v_fmac_f32 v6, v35, v35
    v_fmac_f32 v5, v36, v36
    v_fmac_f32 v6, v37, v37
    v_fmac_f32 v5, v38, v38
    v_fmac_f32 v6, v39, v39
    v_fmac_f32 v5, v40, v40
    v_fmac_f32 v6, v41, v41
    v_fmac_f32 v5, v42, v42
    v_fmac_f32 v6, v43, v43
    v_fmac_f32 v5, v44, v44
    v_fmac_f32 v6, v45, v45
    v_fmac_f32 v5, v46, v46
    v_fmac_f32 v6, v47, v47
    v_add_f32 v5, v5, v6
    s_nop 1
    v_add_f32_dpp v5, v5, v5 row_ror:8 row_mask:0xf bank_mask:0xf
    s_nop 1
    v_add_f32_dpp v5, v5, v5 row_ror:4 row_mask:0xf bank_mask:0xf
    s_nop 1
    v_add_f32_dpp v5, v5, v5 row_ror:2 row_mask:0xf bank_mask:0xf
    s_nop 1
    v_add_f32_dpp v5, v5, v5 row_ror:1 row_mask:0xf bank_mask:0xf
    v_mov_b32 v6, v5
    s_nop 1
    v_permlane16_swap_b32 v5, v6
    v_add_f32 v5, v5, v6
    v_mul_f32 v5, 0x3b000000, v5
    v_cvt_pk_bf16_f32 v4, v4, v5
    v_and_b32 v5, s63, v4
    v_lshlrev_b32 v4, 16, v4
    v_add_f32 v5, 0x3727c5ac, v5
    v_cvt_pk_bf16_f32 v5, v5, v5
    v_and_b32 v5, s63, v5
    v_sqrt_f32 v5, v5
    s_nop 0
    v_cvt_pk_bf16_f32 v5, v5, v5
    v_and_b32 v5, s63, v5
    v_rcp_f32 v5, v5
    v_sub_f32 v16, v16, v4
    v_sub_f32 v17, v17, v4
    v_sub_f32 v18, v18, v4
    v_sub_f32 v19, v19, v4
    v_sub_f32 v20, v20, v4
    v_sub_f32 v21, v21, v4
    v_sub_f32 v22, v22, v4
    v_sub_f32 v23, v23, v4
    v_sub_f32 v24, v24, v4
    v_sub_f32 v25, v25, v4
    v_sub_f32 v26, v26, v4
    v_sub_f32 v27, v27, v4
    v_sub_f32 v28, v28, v4
    v_sub_f32 v29, v29, v4
    v_sub_f32 v30, v30, v4
    v_sub_f32 v31, v31, v4
    v_cvt_pk_bf16_f32 v32, v16, v17
    v_cvt_pk_bf16_f32 v33, v18, v19
    v_cvt_pk_bf16_f32 v34, v20, v21
    v_cvt_pk_bf16_f32 v35, v22, v23
    v_cvt_pk_bf16_f32 v36, v24, v25
    v_cvt_pk_bf16_f32 v37, v26, v27
    v_cvt_pk_bf16_f32 v38, v28, v29
    v_cvt_pk_bf16_f32 v39, v30, v31
    v_lshlrev_b32 v16, 16, v32
    v_and_b32 v17, s63, v32
    v_lshlrev_b32 v18, 16, v33
    v_and_b32 v19, s63, v33
    v_lshlrev_b32 v20, 16, v34
    v_and_b32 v21, s63, v34
    v_lshlrev_b32 v22, 16, v35
    v_and_b32 v23, s63, v35
    v_lshlrev_b32 v24, 16, v36
    v_and_b32 v25, s63, v36
    v_lshlrev_b32 v26, 16, v37
    v_and_b32 v27, s63, v37
    v_lshlrev_b32 v28, 16, v38
    v_and_b32 v29, s63, v38
    v_lshlrev_b32 v30, 16, v39
    v_and_b32 v31, s63, v39
    v_mul_f32 v16, v16, v5
    v_mul_f32 v17, v17, v5
    v_mul_f32 v18, v18, v5
    v_mul_f32 v19, v19, v5
    v_mul_f32 v20, v20, v5
    v_mul_f32 v21, v21, v5
    v_mul_f32 v22, v22, v5
    v_mul_f32 v23, v23, v5
    v_mul_f32 v24, v24, v5
    v_mul_f32 v25, v25, v5
    v_mul_f32 v26, v26, v5
    v_mul_f32 v27, v27, v5
    v_mul_f32 v28, v28, v5
    v_mul_f32 v29, v29, v5
    v_mul_f32 v30, v30, v5
    v_mul_f32 v31, v31, v5
    v_cvt_pk_bf16_f32 v32, v16, v17
    v_cvt_pk_bf16_f32 v33, v18, v19
    v_cvt_pk_bf16_f32 v34, v20, v21
    v_cvt_pk_bf16_f32 v35, v22, v23
    v_cvt_pk_bf16_f32 v36, v24, v25
    v_cvt_pk_bf16_f32 v37, v26, v27
    v_cvt_pk_bf16_f32 v38, v28, v29
    v_cvt_pk_bf16_f32 v39, v30, v31
    ds_write_b64 v13, v[32:33] offset:0
    ds_write_b64 v13, v[34:35] offset:16
    ds_write_b64 v13, v[36:37] offset:32
    ds_write_b64 v13, v[38:39] offset:48
    s_mov_b64 exec, 1
    ds_write_b32 v2, v3 offset:7196
    ds_write_b32 v2, v60 offset:7172
    s_mov_b64 exec, -1
    v_mov_b32 v1, v3
    v_and_b32 v3, s65, v3
    s_mov_b32 s73, 10
L_hello13:
    s_waitcnt vmcnt(0)
    v_cmp_eq_u32 vcc, 0, v58
    s_cbranch_vccz L_hellod14
    v_cmp_ne_u32 s[74:75], v58, v56
    s_andn2_b64 s[74:75], s[74:75], vcc
    s_cbranch_scc1 L_hellod14
    s_sub_u32 s73, s73, 1
    s_cbranch_scc1 L_hellod14
    buffer_load_ubyte v58, v57, s[48:51], s71 offen sc1
    s_branch L_hello13
L_hellod14:
    v_cmp_ne_u32 vcc, v58, v56
    s_nop 3
    s_cmp_eq_u64 vcc, 0
    s_cselect_b32 s64, 2, 1
    s_mov_b64 exec, 1
    v_mov_b32 v4, s64
    ds_write_b32 v2, v4 offset:7200
    s_mov_b64 exec, -1
    s_lshl_b32 s33, s28, 2
    s_lshr_b32 s34, s29, 3
    s_add_u32 s33, s33, s34
    s_lshl_b32 s33, s33, 13
    s_and_b32 s34, s29, 7
    s_lshl_b32 s34, s34, 4
    s_add_u32 s33, s33, s34
    s_add_u32 s76, s33, 921600
    v_lshlrev_b32 v57, 7, v0
    v_lshlrev_b32 v61, 16, v61
    s_min_u32 s70, s28, 4
    s_mul_i32 s71, s28, 3
    s_add_u32 s71, s71, s70
    s_lshr_b32 s70, s29, 3
    s_add_u32 s71, s71, s70
    s_and_b32 s72, s29, 7
    s_cmp_lt_u32 s28, 4
    s_cselect_b32 s70, 32, 24
    s_cmp_lt_u32 s29, s70
    s_cbranch_scc1 L_hasglu
    s_mov_b64 exec, 1
    ds_add_u32 v2, v60 offset:7180
    s_mov_b64 exec, -1
    s_branch L_final
L_hasglu:
    v_lshrrev_b32 v4, 4, v0
    v_and_b32 v5, 1, v0
    v_mul_u32_u24 v6, 1088, v5
    v_lshl_add_u32 v6, v4, 4, v6
    s_lshl_b32 s33, s72, 7
    s_add_u32 s33, s33, 155648
    v_add_u32 v6, s33, v6
    ds_read_b128 v[8:11], v6
    ds_read_b128 v[12:15], v6 offset:64
    v_lshlrev_b32 v63, 4, v4
    v_lshl_add_u32 v63, v5, 9, v63
    v_bfe_u32 v17, v0, 2, 2
    v_lshrrev_b32 v18, 4, v0
    v_lshl_add_u32 v17, v18, 2, v17
    v_bfe_u32 v18, v17, 1, 2
    v_lshlrev_b32 v18, 5, v18
    v_lshl_add_u32 v16, v17, 7, v18
    v_and_b32 v19, 3, v0
    v_lshl_add_u32 v16, v19, 3, v16
    v_xor_b32 v17, 0x20, v16
    v_xor_b32 v18, 0x40, v16
    v_xor_b32 v19, 0x60, v16
    s_lshl_b32 s33, s71, 13
    s_add_u32 s74, s33, 135168
    s_lshl_b32 s34, s72, 10
    s_add_u32 s73, s74, s34
    s_add_u32 s75, s74, 4096
L_w15:
    s_sub_u32 s67, s67, 1
    s_cbranch_scc1 L_abort
    ds_read_b32 v20, v2 offset:7168
    s_waitcnt lgkmcnt(0)
    v_cmp_le_i32 vcc, 32, v20
    s_cbranch_vccz L_w15
    ds_read_b64_tr_b16 v[64:65], v16 offset:16384
    ds_read_b64_tr_b16 v[66:67], v16 offset:18432
    ds_read_b64_tr_b16 v[68:69], v16 offset:20480
    ds_read_b64_tr_b16 v[70:71], v16 offset:22528
    ds_read_b64_tr_b16 v[72:73], v17 offset:16384
    ds_read_b64_tr_b16 v[74:75], v17 offset:18432
    ds_read_b64_tr_b16 v[76:77], v17 offset:20480
    ds_read_b64_tr_b16 v[78:79], v17 offset:22528
    ds_read_b64_tr_b16 v[80:81], v18 offset:16384
    ds_read_b64_tr_b16 v[82:83], v18 offset:18432
    ds_read_b64_tr_b16 v[84:85], v18 offset:20480
    ds_read_b64_tr_b16 v[86:87], v18 offset:22528
    ds_read_b64_tr_b16 v[88:89], v19 offset:16384
    ds_read_b64_tr_b16 v[90:91], v19 offset:18432
    ds_read_b64_tr_b16 v[92:93], v19 offset:20480
    ds_read_b64_tr_b16 v[94:95], v19 offset:22528
    s_waitcnt lgkmcnt(0)
    v_mfma_f32_16x16x32_bf16 v[24:27], v[64:67], v[8:11], 0
    v_mfma_f32_16x16x32_bf16 v[28:31], v[72:75], v[8:11], 0
    v_mfma_f32_16x16x32_bf16 v[32:35], v[80:83], v[8:11], 0
    v_mfma_f32_16x16x32_bf16 v[36:39], v[88:91], v[8:11], 0
    v_mfma_f32_16x16x32_bf16 v[24:27], v[68:71], v[12:15], v[24:27]
    v_mfma_f32_16x16x32_bf16 v[28:31], v[76:79], v[12:15], v[28:31]
    v_mfma_f32_16x16x32_bf16 v[32:35], v[84:87], v[12:15], v[32:35]
    v_mfma_f32_16x16x32_bf16 v[36:39], v[92:95], v[12:15], v[36:39]
    s_nop 3
    ds_read_b64_tr_b16 v[64:65], v16 offset:24576
    ds_read_b64_tr_b16 v[66:67], v16 offset:26624
    ds_read_b64_tr_b16 v[68:69], v16 offset:28672
    ds_read_b64_tr_b16 v[70:71], v16 offset:30720
    ds_read_b64_tr_b16 v[72:73], v17 offset:24576
    ds_read_b64_tr_b16 v[74:75], v17 offset:26624
    ds_read_b64_tr_b16 v[76:77], v17 offset:28672
    ds_read_b64_tr_b16 v[78:79], v17 offset:30720
    ds_read_b64_tr_b16 v[80:81], v18 offset:24576
    ds_read_b64_tr_b16 v[82:83], v18 offset:26624
    ds_read_b64_tr_b16 v[84:85], v18 offset:28672
    ds_read_b64_tr_b16 v[86:87], v18 offset:30720
    ds_read_b64_tr_b16 v[88:89], v19 offset:24576
    ds_read_b64_tr_b16 v[90:91], v19 offset:26624
    ds_read_b64_tr_b16 v[92:93], v19 offset:28672
    ds_read_b64_tr_b16 v[94:95], v19 offset:30720
    s_waitcnt lgkmcnt(0)
    s_mov_b64 exec, 1
    ds_add_u32 v2, v60 offset:7180
    s_mov_b64 exec, -1
    v_mfma_f32_16x16x32_bf16 v[40:43], v[64:67], v[8:11], 0
    v_mfma_f32_16x16x32_bf16 v[44:47], v[72:75], v[8:11], 0
    v_mfma_f32_16x16x32_bf16 v[48:51], v[80:83], v[8:11], 0
    v_mfma_f32_16x16x32_bf16 v[52:55], v[88:91], v[8:11], 0
    v_mfma_f32_16x16x32_bf16 v[40:43], v[68:71], v[12:15], v[40:43]
    v_mfma_f32_16x16x32_bf16 v[44:47], v[76:79], v[12:15], v[44:47]
    v_mfma_f32_16x16x32_bf16 v[48:51], v[84:87], v[12:15], v[48:51]
    v_mfma_f32_16x16x32_bf16 v[52:55], v[92:95], v[12:15], v[52:55]
    v_bfi_b32 v24, s65, v3, v24
    v_bfi_b32 v25, s65, v3, v25
    v_bfi_b32 v26, s65, v3, v26
    v_bfi_b32 v27, s65, v3, v27
    v_bfi_b32 v28, s65, v3, v28
    v_bfi_b32 v29, s65, v3, v29
    v_bfi_b32 v30, s65, v3, v30
    v_bfi_b32 v31, s65, v3, v31
    v_bfi_b32 v32, s65, v3, v32
    v_bfi_b32 v33, s65, v3, v33
    v_bfi_b32 v34, s65, v3, v34
    v_bfi_b32 v35, s65, v3, v35
    v_bfi_b32 v36, s65, v3, v36
    v_bfi_b32 v37, s65, v3, v37
    v_bfi_b32 v38, s65, v3, v38
    v_bfi_b32 v39, s65, v3, v39
    v_bfi_b32 v40, s65, v3, v40
    v_bfi_b32 v41, s65, v3, v41
    v_bfi_b32 v42, s65, v3, v42
    v_bfi_b32 v43, s65, v3, v43
    v_bfi_b32 v44, s65, v3, v44
    v_bfi_b32 v45, s65, v3, v45
    v_bfi_b32 v46, s65, v3, v46
    v_bfi_b32 v47, s65, v3, v47
    v_bfi_b32 v48, s65, v3, v48
    v_bfi_b32 v49, s65, v3, v49
    v_bfi_b32 v50, s65, v3, v50
    v_bfi_b32 v51, s65, v3, v51
    v_bfi_b32 v52, s65, v3, v52
    v_bfi_b32 v53, s65, v3, v53
    v_bfi_b32 v54, s65, v3, v54
    v_bfi_b32 v55, s65, v3, v55
    s_mov_b32 exec_lo, 0x30003
    s_mov_b32 exec_hi, 0x30003
    s_cmp_eq_u32 s64, 2
    s_cbranch_scc0 L_far16
    buffer_store_dwordx4 v[24:27], v63, s[40:43], s73 offen offset:0
    buffer_store_dwordx4 v[28:31], v63, s[40:43], s73 offen offset:64
    buffer_store_dwordx4 v[32:35], v63, s[40:43], s73 offen offset:128
    buffer_store_dwordx4 v[36:39], v63, s[40:43], s73 offen offset:192
    buffer_store_dwordx4 v[40:43], v63, s[40:43], s73 offen offset:256
    buffer_store_dwordx4 v[44:47], v63, s[40:43], s73 offen offset:320
    buffer_store_dwordx4 v[48:51], v63, s[40:43], s73 offen offset:384
    buffer_store_dwordx4 v[52:55], v63, s[40:43], s73 offen offset:448
L_pub17:
    s_mov_b64 exec, -1
    v_lshlrev_b32 v6, 4, v0
    v_lshrrev_b32 v7, 5, v0
    v_mul_u32_u24 v7, 192, v7
    v_and_b32 v8, 3, v0
    v_lshl_add_u32 v7, v8, 4, v7
    v_bfe_u32 v8, v0, 2, 1
    v_lshl_add_u32 v7, v8, 3, v7
    v_bfe_u32 v8, v0, 3, 1
    v_lshl_add_u32 v7, v8, 6, v7
    v_add_u32 v7, v2, v7
    v_mul_u32_u24 v59, 192, v5
    v_lshl_add_u32 v59, v4, 4, v59
    v_add_u32 v59, v2, v59
L_w18:
    s_sub_u32 s67, s67, 1
    s_cbranch_scc1 L_abort
    ds_read_b32 v10, v2 offset:7168
    s_waitcnt lgkmcnt(0)
    v_cmp_le_i32 vcc, 128, v10
    s_cbranch_vccz L_w18
    buffer_load_dwordx4 v[64:67], v6, s[40:43], s74 offen offset:0 sc1 nt
    buffer_load_dwordx4 v[68:71], v6, s[40:43], s74 offen offset:1024 sc1 nt
    buffer_load_dwordx4 v[72:75], v6, s[40:43], s74 offen offset:2048 sc1 nt
    buffer_load_dwordx4 v[76:79], v6, s[40:43], s74 offen offset:3072 sc1 nt
    buffer_load_dwordx4 v[80:83], v6, s[40:43], s75 offen offset:0 sc1 nt
    buffer_load_dwordx4 v[84:87], v6, s[40:43], s75 offen offset:1024 sc1 nt
    buffer_load_dwordx4 v[88:91], v6, s[40:43], s75 offen offset:2048 sc1 nt
    buffer_load_dwordx4 v[92:95], v6, s[40:43], s75 offen offset:3072 sc1 nt
    s_branch L_pc20
L_p19:
    s_sub_u32 s67, s67, 16
    s_cbranch_scc1 L_abort
    buffer_load_dwordx4 v[64:67], v6, s[40:43], s74 offen offset:0 sc1
    buffer_load_dwordx4 v[68:71], v6, s[40:43], s74 offen offset:1024 sc1
    buffer_load_dwordx4 v[72:75], v6, s[40:43], s74 offen offset:2048 sc1
    buffer_load_dwordx4 v[76:79], v6, s[40:43], s74 offen offset:3072 sc1
    buffer_load_dwordx4 v[80:83], v6, s[40:43], s75 offen offset:0 sc1
    buffer_load_dwordx4 v[84:87], v6, s[40:43], s75 offen offset:1024 sc1
    buffer_load_dwordx4 v[88:91], v6, s[40:43], s75 offen offset:2048 sc1
    buffer_load_dwordx4 v[92:95], v6, s[40:43], s75 offen offset:3072 sc1
L_pc20:
    s_waitcnt vmcnt(0)
    v_bitop3_b32 v24, v64, v65, v3 bitop3:0x7e
    v_bitop3_b32 v25, v66, v67, v3 bitop3:0x7e
    v_bitop3_b32 v26, v68, v69, v3 bitop3:0x7e
    v_bitop3_b32 v27, v70, v71, v3 bitop3:0x7e
    v_bitop3_b32 v28, v72, v73, v3 bitop3:0x7e
    v_bitop3_b32 v29, v74, v75, v3 bitop3:0x7e
    v_bitop3_b32 v30, v76, v77, v3 bitop3:0x7e
    v_bitop3_b32 v31, v78, v79, v3 bitop3:0x7e
    v_bitop3_b32 v32, v80, v81, v3 bitop3:0x7e
    v_bitop3_b32 v33, v82, v83, v3 bitop3:0x7e
    v_bitop3_b32 v34, v84, v85, v3 bitop3:0x7e
    v_bitop3_b32 v35, v86, v87, v3 bitop3:0x7e
    v_bitop3_b32 v36, v88, v89, v3 bitop3:0x7e
    v_bitop3_b32 v37, v90, v91, v3 bitop3:0x7e
    v_bitop3_b32 v38, v92, v93, v3 bitop3:0x7e
    v_bitop3_b32 v39, v94, v95, v3 bitop3:0x7e
    v_or3_b32 v24, v24, v25, v26
    v_or3_b32 v27, v27, v28, v29
    v_or3_b32 v30, v30, v31, v32
    v_or3_b32 v33, v33, v34, v35
    v_or3_b32 v36, v36, v37, v38
    v_or3_b32 v24, v24, v27, v30
    v_or3_b32 v33, v33, v36, v39
    v_or_b32 v24, v24, v33
    v_and_b32 v24, s65, v24
    v_cmp_ne_u32 vcc, 0, v24
    s_cbranch_vccnz L_p19
    v_add_f32 v64, v64, v80
    v_add_f32 v65, v65, v81
    v_add_f32 v66, v66, v82
    v_add_f32 v67, v67, v83
    v_add_f32 v68, v68, v84
    v_add_f32 v69, v69, v85
    v_add_f32 v70, v70, v86
    v_add_f32 v71, v71, v87
    v_add_f32 v72, v72, v88
    v_add_f32 v73, v73, v89
    v_add_f32 v74, v74, v90
    v_add_f32 v75, v75, v91
    v_add_f32 v76, v76, v92
    v_add_f32 v77, v77, v93
    v_add_f32 v78, v78, v94
    v_add_f32 v79, v79, v95
    v_add_f32 v64, v64, v72
    v_add_f32 v65, v65, v73
    v_add_f32 v66, v66, v74
    v_add_f32 v67, v67, v75
    v_add_f32 v68, v68, v76
    v_add_f32 v69, v69, v77
    v_add_f32 v70, v70, v78
    v_add_f32 v71, v71, v79
    v_add_f32 v64, v64, v68
    v_add_f32 v65, v65, v69
    v_add_f32 v66, v66, v70
    v_add_f32 v67, v67, v71
    v_cvt_pk_bf16_f32 v64, v64, v65
    v_cvt_pk_bf16_f32 v66, v66, v67
    v_mov_b32 v68, v64
    v_mov_b32 v70, v66
    s_nop 0
    v_permlane16_swap_b32 v64, v68
    v_permlane16_swap_b32 v66, v70
    v_and_b32 v67, s63, v66
    v_lshlrev_b32 v66, 16, v66
    v_and_b32 v65, s63, v64
    v_lshlrev_b32 v64, 16, v64
    v_and_b32 v71, s63, v70
    v_lshlrev_b32 v70, 16, v70
    v_and_b32 v69, s63, v68
    v_lshlrev_b32 v68, 16, v68
    v_mul_f32 v64, 0xbfb8aa3b, v64
    v_mul_f32 v65, 0xbfb8aa3b, v65
    v_mul_f32 v66, 0xbfb8aa3b, v66
    v_mul_f32 v67, 0xbfb8aa3b, v67
    v_exp_f32 v64, v64
    v_exp_f32 v65, v65
    v_exp_f32 v66, v66
    v_exp_f32 v67, v67
    v_add_f32 v64, 1.0, v64
    v_add_f32 v65, 1.0, v65
    v_add_f32 v66, 1.0, v66
    v_add_f32 v67, 1.0, v67
    v_rcp_f32 v64, v64
    v_rcp_f32 v65, v65
    v_rcp_f32 v66, v66
    v_rcp_f32 v67, v67
    v_cvt_pk_bf16_f32 v64, v64, v65
    v_cvt_pk_bf16_f32 v66, v66, v67
    v_and_b32 v67, s63, v66
    v_lshlrev_b32 v66, 16, v66
    v_and_b32 v65, s63, v64
    v_lshlrev_b32 v64, 16, v64
    v_mul_f32 v64, v64, v68
    v_mul_f32 v65, v65, v69
    v_mul_f32 v66, v66, v70
    v_mul_f32 v67, v67, v71
    v_cvt_pk_bf16_f32 v64, v64, v65
    v_cvt_pk_bf16_f32 v65, v66, v67
    s_mov_b32 exec_lo, 0xffff
    s_mov_b32 exec_hi, 0xffff
    ds_write_b64 v7, v[64:65] offset:6784
    s_mov_b64 exec, -1
    ds_read_b128 v[8:11], v59 offset:6784
    ds_read_b128 v[12:15], v59 offset:6848
    v_lshlrev_b32 v63, 4, v4
    v_lshl_add_u32 v63, v5, 6, v63
    s_lshl_b32 s33, s71, 7
    s_add_u32 s72, s72, 5
    s_and_b32 s72, s72, 7
    s_lshl_b32 s34, s72, 15
    s_add_u32 s73, s33, s34
    s_add_u32 s72, s73, 925696
    s_add_u32 s73, s72, 8192
    s_add_u32 s74, s73, 8192
    s_add_u32 s75, s74, 8192
L_w21:
    s_sub_u32 s67, s67, 1
    s_cbranch_scc1 L_abort
    ds_read_b32 v20, v2 offset:7168
    s_waitcnt lgkmcnt(0)
    v_cmp_le_i32 vcc, 168, v20
    s_cbranch_vccz L_w21
    ds_read_b64_tr_b16 v[64:65], v16 offset:16384
    ds_read_b64_tr_b16 v[66:67], v16 offset:18432
    ds_read_b64_tr_b16 v[68:69], v16 offset:20480
    ds_read_b64_tr_b16 v[70:71], v16 offset:22528
    ds_read_b64_tr_b16 v[72:73], v17 offset:16384
    ds_read_b64_tr_b16 v[74:75], v17 offset:18432
    ds_read_b64_tr_b16 v[76:77], v17 offset:20480
    ds_read_b64_tr_b16 v[78:79], v17 offset:22528
    ds_read_b64_tr_b16 v[80:81], v18 offset:16384
    ds_read_b64_tr_b16 v[82:83], v18 offset:18432
    ds_read_b64_tr_b16 v[84:85], v18 offset:20480
    ds_read_b64_tr_b16 v[86:87], v18 offset:22528
    ds_read_b64_tr_b16 v[88:89], v19 offset:16384
    ds_read_b64_tr_b16 v[90:91], v19 offset:18432
    ds_read_b64_tr_b16 v[92:93], v19 offset:20480
    ds_read_b64_tr_b16 v[94:95], v19 offset:22528
    s_waitcnt lgkmcnt(12)
    v_mfma_f32_16x16x32_bf16 v[24:27], v[64:67], v[8:11], 0
    s_waitcnt lgkmcnt(8)
    v_mfma_f32_16x16x32_bf16 v[28:31], v[72:75], v[8:11], 0
    s_waitcnt lgkmcnt(4)
    v_mfma_f32_16x16x32_bf16 v[32:35], v[80:83], v[8:11], 0
    s_waitcnt lgkmcnt(0)
    v_mfma_f32_16x16x32_bf16 v[36:39], v[88:91], v[8:11], 0
    v_mfma_f32_16x16x32_bf16 v[24:27], v[68:71], v[12:15], v[24:27]
    v_mfma_f32_16x16x32_bf16 v[28:31], v[76:79], v[12:15], v[28:31]
    v_mfma_f32_16x16x32_bf16 v[32:35], v[84:87], v[12:15], v[32:35]
    v_mfma_f32_16x16x32_bf16 v[36:39], v[92:95], v[12:15], v[36:39]
    s_nop 4
    v_bfi_b32 v24, s65, v3, v24
    v_bfi_b32 v25, s65, v3, v25
    v_bfi_b32 v26, s65, v3, v26
    v_bfi_b32 v27, s65, v3, v27
    v_bfi_b32 v28, s65, v3, v28
    v_bfi_b32 v29, s65, v3, v29
    v_bfi_b32 v30, s65, v3, v30
    v_bfi_b32 v31, s65, v3, v31
    v_bfi_b32 v32, s65, v3, v32
    v_bfi_b32 v33, s65, v3, v33
    v_bfi_b32 v34, s65, v3, v34
    v_bfi_b32 v35, s65, v3, v35
    v_bfi_b32 v36, s65, v3, v36
    v_bfi_b32 v37, s65, v3, v37
    v_bfi_b32 v38, s65, v3, v38
    v_bfi_b32 v39, s65, v3, v39
    s_mov_b32 exec_lo, 0x30003
    s_mov_b32 exec_hi, 0x30003
    buffer_store_dwordx4 v[24:27], v63, s[40:43], s72 offen sc1
    buffer_store_dwordx4 v[28:31], v63, s[40:43], s73 offen sc1
    buffer_store_dwordx4 v[32:35], v63, s[40:43], s74 offen sc1
    buffer_store_dwordx4 v[36:39], v63, s[40:43], s75 offen sc1
    s_mov_b64 exec, -1
L_final:
    v_mov_b32 v8, 0
    v_mov_b32 v9, 0
    v_mov_b32 v10, 0
    v_mov_b32 v11, 0
    s_barrier
    s_setprio 2
    s_mov_b32 exec_lo, 0xffffffff
    s_mov_b32 exec_hi, 0xfffffff
    s_barrier
L_p22:
    s_sub_u32 s67, s67, 16
    s_cbranch_scc1 L_abort
    buffer_load_dwordx4 v[8:11], v57, s[40:43], s76 offen sc1
    s_waitcnt vmcnt(0)
    v_bitop3_b32 v12, v8, v9, v3 bitop3:0x7e
    v_bitop3_b32 v13, v10, v11, v3 bitop3:0x7e
    v_or_b32 v12, v12, v13
    v_and_b32 v12, s65, v12
    v_cmp_ne_u32 vcc, 0, v12
    s_cbranch_vccnz L_p22
    s_mov_b64 exec, -1
    v_permlane16_swap_b32 v8, v9
    v_permlane16_swap_b32 v10, v11
    v_add_f32 v8, v8, v9
    v_add_f32 v10, v10, v11
    s_nop 0
    v_add_f32_dpp v12, v8, v8 row_ror:8 row_mask:0xf bank_mask:0x3
    s_nop 1
    v_add_f32_dpp v12, v10, v10 row_ror:8 row_mask:0xf bank_mask:0xc
    s_nop 1
    v_add_f32_dpp v12, v12, v12 row_half_mirror row_mask:0xf bank_mask:0xf
    s_nop 1
    v_add_f32_dpp v12, v12, v12 quad_perm:[1,0,3,2] row_mask:0xf bank_mask:0xf
    s_nop 1
    v_add_f32_dpp v12, v12, v12 quad_perm:[2,3,0,1] row_mask:0xf bank_mask:0xf
    v_cvt_pk_bf16_f32 v14, 0, v12
    v_cvt_pk_bf16_f32 v12, 0, v12
    s_mov_b32 s34, 0x01010101
    s_nop 0
    v_permlane32_swap_b32 v12, v14
    v_mul_f32 v9, 0xbfb8aa3b, v14
    v_exp_f32 v9, v9
    s_mov_b32 exec_lo, s34
    v_add_f32 v9, 1.0, v9
    v_rcp_f32 v9, v9
    s_mov_b32 exec_hi, 0
    v_mul_f32 v14, v14, v9
    v_cvt_pk_bf16_f32 v14, 0, v14
    v_mul_f32 v12, v12, v14
    v_cvt_pk_bf16_f32 v12, 0, v12
    v_add_f32 v12, v12, v61
    v_cvt_pk_bf16_f32 v12, v12, v12
    buffer_store_short v12, v62, s[44:47], 0 offen
    s_cmp_lg_u32 s2, 0
    s_cbranch_scc1 L_noepoch
    s_mov_b64 exec, 1
    buffer_store_dword v1, off, s[40:43], 0
L_noepoch:
    s_endpgm
L_far16:
    buffer_store_dwordx4 v[24:27], v63, s[40:43], s73 offen offset:0 sc1
    buffer_store_dwordx4 v[28:31], v63, s[40:43], s73 offen offset:64 sc1
    buffer_store_dwordx4 v[32:35], v63, s[40:43], s73 offen offset:128 sc1
    buffer_store_dwordx4 v[36:39], v63, s[40:43], s73 offen offset:192 sc1
    buffer_store_dwordx4 v[40:43], v63, s[40:43], s73 offen offset:256 sc1
    buffer_store_dwordx4 v[44:47], v63, s[40:43], s73 offen offset:320 sc1
    buffer_store_dwordx4 v[48:51], v63, s[40:43], s73 offen offset:384 sc1
    buffer_store_dwordx4 v[52:55], v63, s[40:43], s73 offen offset:448 sc1
    s_branch L_pub17
L_cwave:
    s_sub_u32 s70, s30, 2
    v_mov_b32 v2, 0x26000
    v_mov_b32 v5, 1
    s_movk_i32 s65, 0x3ff
    s_movk_i32 s66, 0xff
    s_mov_b32 s63, 0xffff0000
    v_lshrrev_b32 v6, 4, v0
    v_lshlrev_b32 v6, 4, v6
    v_bfe_u32 v7, v0, 2, 2
    v_and_b32 v8, 15, v0
    v_lshrrev_b32 v11, 4, v0
    v_xor_b32 v11, v8, v11
    v_lshlrev_b32 v11, 4, v11
    v_lshl_add_u32 v11, v8, 8, v11
    s_lshl_b32 s33, s70, 13
    s_add_u32 s33, s33, 32768
    v_add_u32 v12, s33, v11
    v_xor_b32 v13, 0x40, v12
    v_xor_b32 v14, 0x80, v12
    v_xor_b32 v15, 0xc0, v12
    v_mul_u32_u24 v16, 320, v7
    v_add3_u32 v16, v16, v6, v2
    v_lshl_add_u32 v18, v7, 5, v2
    s_lshl_b32 s33, s70, 2
    v_add_u32 v17, s33, v18
    v_mul_u32_u24 v20, 576, v7
    v_add3_u32 v20, v20, v6, v2
    s_lshl_b32 s33, s70, 6
    v_add_u32 v19, s33, v20
    v_bfe_u32 v25, v0, 2, 2
    v_lshrrev_b32 v26, 4, v0
    v_lshl_add_u32 v25, v26, 2, v25
    v_and_b32 v26, 7, v25
    v_lshlrev_b32 v26, 5, v26
    v_lshl_add_u32 v24, v25, 8, v26
    v_and_b32 v27, 3, v0
    v_lshl_add_u32 v24, v27, 3, v24
    s_lshl_b32 s33, s70, 6
    s_and_b32 s33, s33, 0xc0
    v_xor_b32 v24, s33, v24
    v_add_u32 v21, 0x18000, v24
    v_add_u32 v22, 0x6000, v24
    v_lshl_add_u32 v23, v7, 14, v6
    v_and_b32 v25, 1, v0
    v_lshl_add_u32 v23, v25, 6, v23
    s_lshl_b32 s33, s28, 16
    s_lshl_b32 s34, s31, 13
    s_add_u32 s33, s33, s34
    s_lshl_b32 s34, s32, 9
    s_add_u32 s33, s33, s34
    s_add_u32 s76, s33, 397312
    s_lshl_b32 s34, s70, 7
    s_add_u32 s71, s76, s34
    s_lshl_b32 s33, s28, 11
    s_lshl_b32 s34, s31, 8
    s_add_u32 s33, s33, s34
    s_lshl_b32 s34, s32, 4
    s_add_u32 s33, s33, s34
    s_add_u32 s77, s33, 364544
    v_bfe_u32 v25, v0, 2, 2
    v_lshrrev_b32 v26, 4, v0
    v_lshl_add_u32 v25, v26, 2, v25
    v_bfe_u32 v26, v25, 1, 2
    v_lshlrev_b32 v26, 5, v26
    v_lshl_add_u32 v11, v25, 7, v26
    v_and_b32 v27, 3, v0
    v_lshl_add_u32 v11, v27, 3, v11
    s_lshl_b32 s33, s70, 5
    v_xor_b32 v11, s33, v11
    s_waitcnt lgkmcnt(0)
    s_mov_b32 s40, s26
    s_mov_b32 s41, s27
    s_mov_b32 s42, 2097152
    s_mov_b32 s43, 0x20000
    s_barrier
L_w23:
    s_sub_u32 s67, s67, 1
    s_cbranch_scc1 L_abort
    ds_read_b32 v8, v2 offset:7172
    s_waitcnt lgkmcnt(0)
    v_cmp_le_i32 vcc, 1, v8
    s_cbranch_vccz L_w23
    ds_read_b32 v3, v2 offset:7196
    s_cmp_ge_u32 s70, 4
    s_cbranch_scc1 L_noq
    v_and_b32 v26, 1, v0
    v_mul_u32_u24 v25, 1088, v26
    v_add_u32 v25, v25, v6
    s_lshr_b32 s34, s29, 3
    s_lshl_b32 s33, s34, 8
    s_add_u32 s33, s33, 155648
    v_add_u32 v25, s33, v25
    ds_read_b128 v[32:35], v25 offset:0
    ds_read_b128 v[36:39], v25 offset:64
    ds_read_b128 v[40:43], v25 offset:128
    ds_read_b128 v[44:47], v25 offset:192
    v_lshl_add_u32 v26, v26, 13, v6
    s_lshl_b32 s33, s28, 14
    s_lshl_b32 s34, s34, 11
    s_add_u32 s72, s33, s34
    s_and_b32 s34, s29, 7
    s_lshl_b32 s34, s34, 8
    s_add_u32 s72, s72, s34
    s_lshl_b32 s34, s70, 6
    s_add_u32 s72, s72, s34
    s_add_u32 s72, s72, 4096
    s_lshl_b32 s34, s31, 13
    s_add_u32 s33, s33, s34
    s_lshl_b32 s34, s70, 9
    s_add_u32 s33, s33, s34
    s_add_u32 s73, s33, 4096
    s_add_u32 s74, s73, 4096
    v_lshrrev_b32 v27, 5, v0
    v_and_b32 v28, 31, v0
    v_lshlrev_b32 v27, 11, v27
    v_lshl_add_u32 v27, v28, 4, v27
    s_mul_i32 s33, s70, 320
    s_add_u32 s33, s33, 157952
    v_lshl_add_u32 v28, v28, 3, s33
L_w24:
    s_sub_u32 s67, s67, 1
    s_cbranch_scc1 L_abort
    ds_read_b32 v8, v2 offset:7168
    s_waitcnt lgkmcnt(0)
    v_cmp_le_i32 vcc, 16, v8
    s_cbranch_vccz L_w24
    ds_read_b64_tr_b16 v[48:49], v11 offset:0
    ds_read_b64_tr_b16 v[50:51], v11 offset:2048
    ds_read_b64_tr_b16 v[52:53], v11 offset:4096
    ds_read_b64_tr_b16 v[54:55], v11 offset:6144
    ds_read_b64_tr_b16 v[56:57], v11 offset:8192
    ds_read_b64_tr_b16 v[58:59], v11 offset:10240
    ds_read_b64_tr_b16 v[60:61], v11 offset:12288
    ds_read_b64_tr_b16 v[62:63], v11 offset:14336
    v_and_b32 v4, s66, v3
    s_waitcnt lgkmcnt(6)
    v_mfma_f32_16x16x32_bf16 v[64:67], v[48:51], v[32:35], 0
    s_waitcnt lgkmcnt(4)
    v_mfma_f32_16x16x32_bf16 v[64:67], v[52:55], v[36:39], v[64:67]
    s_waitcnt lgkmcnt(2)
    v_mfma_f32_16x16x32_bf16 v[64:67], v[56:59], v[40:43], v[64:67]
    s_waitcnt lgkmcnt(0)
    v_mfma_f32_16x16x32_bf16 v[64:67], v[60:63], v[44:47], v[64:67]
    s_mov_b64 exec, 1
    ds_add_u32 v2, v5 offset:7176
    s_mov_b64 exec, -1
    s_nop 4
    v_add_u32 v64, 0x80, v64
    v_add_u32 v65, 0x80, v65
    v_add_u32 v66, 0x80, v66
    v_add_u32 v67, 0x80, v67
    v_bfi_b32 v64, s66, v4, v64
    v_bfi_b32 v65, s66, v4, v65
    v_bfi_b32 v66, s66, v4, v66
    v_bfi_b32 v67, s66, v4, v67
L_w25:
    s_sub_u32 s67, s67, 1
    s_cbranch_scc1 L_abort
    ds_read_b32 v8, v2 offset:7200
    s_waitcnt lgkmcnt(0)
    v_cmp_le_i32 vcc, 1, v8
    s_cbranch_vccz L_w25
    v_readfirstlane_b32 s64, v8
    s_mov_b32 exec_lo, 0x30003
    s_mov_b32 exec_hi, 0x30003
    s_cmp_eq_u32 s64, 2
    s_cbranch_scc0 L_far26
    buffer_store_dwordx4 v[64:67], v26, s[40:43], s72 offen
L_pub27:
    s_mov_b64 exec, -1
L_w28:
    s_sub_u32 s67, s67, 1
    s_cbranch_scc1 L_abort
    ds_read_b32 v8, v2 offset:7168
    s_waitcnt lgkmcnt(0)
    v_cmp_le_i32 vcc, 68, v8
    s_cbranch_vccz L_w28
    buffer_load_dwordx4 v[32:35], v27, s[40:43], s73 offen sc1 nt
    buffer_load_dwordx4 v[36:39], v27, s[40:43], s74 offen sc1 nt
    s_branch L_pc30
L_p29:
    s_sub_u32 s67, s67, 16
    s_cbranch_scc1 L_abort
    buffer_load_dwordx4 v[32:35], v27, s[40:43], s73 offen sc1
    buffer_load_dwordx4 v[36:39], v27, s[40:43], s74 offen sc1
L_pc30:
    s_waitcnt vmcnt(0)
    v_bitop3_b32 v40, v32, v33, v4 bitop3:0x7e
    v_bitop3_b32 v41, v34, v35, v4 bitop3:0x7e
    v_bitop3_b32 v42, v36, v37, v4 bitop3:0x7e
    v_bitop3_b32 v43, v38, v39, v4 bitop3:0x7e
    v_or3_b32 v40, v40, v41, v42
    v_or_b32 v40, v40, v43
    v_and_b32 v40, s66, v40
    v_cmp_ne_u32 vcc, 0, v40
    s_cbranch_vccnz L_p29
    v_xor_b32 v32, v4, v32
    v_xor_b32 v33, v4, v33
    v_xor_b32 v34, v4, v34
    v_xor_b32 v35, v4, v35
    v_xor_b32 v36, v4, v36
    v_xor_b32 v37, v4, v37
    v_xor_b32 v38, v4, v38
    v_xor_b32 v39, v4, v39
    v_add_f32 v32, v32, v36
    v_add_f32 v33, v33, v37
    v_add_f32 v34, v34, v38
    v_add_f32 v35, v35, v39
    v_permlane32_swap_b32 v32, v33
    s_nop 0
    v_permlane32_swap_b32 v34, v35
    v_add_f32 v32, v32, v33
    v_add_f32 v34, v34, v35
    v_mov_b32 v33, v32
    v_mov_b32 v35, v34
    s_nop 0
    v_permlane32_swap_b32 v32, v33
    v_permlane32_swap_b32 v34, v35
    v_cvt_pk_bf16_f32 v32, v32, v33
    v_cvt_pk_bf16_f32 v33, v34, v35
    s_mov_b32 exec_lo, 0xffffffff
    s_mov_b32 exec_hi, 0x0
    ds_write_b64 v28, v[32:33]
    s_mov_b64 exec, 1
    ds_add_u32 v2, v5 offset:7184
    s_mov_b64 exec, -1
    s_branch L_scores
L_noq:
L_w31:
    s_sub_u32 s67, s67, 1
    s_cbranch_scc1 L_abort
    ds_read_b32 v8, v2 offset:7200
    s_waitcnt lgkmcnt(0)
    v_cmp_le_i32 vcc, 1, v8
    s_cbranch_vccz L_w31
    v_readfirstlane_b32 s64, v8
L_scores:
    s_waitcnt lgkmcnt(0)
    v_and_b32 v3, s65, v3
    s_lshl_b32 s34, s70, 3
    s_add_u32 s34, s34, 40
L_w32:
    s_sub_u32 s67, s67, 1
    s_cbranch_scc1 L_abort
    ds_read_b32 v8, v2 offset:7168
    s_waitcnt lgkmcnt(0)
    v_cmp_le_i32 vcc, s34, v8
    s_cbranch_vccz L_w32
    ds_read_b128 v[48:51], v12 offset:0
    ds_read_b128 v[52:55], v13 offset:0
    ds_read_b128 v[56:59], v14 offset:0
    ds_read_b128 v[60:63], v15 offset:0
    ds_read_b128 v[64:67], v12 offset:4096
    ds_read_b128 v[68:71], v13 offset:4096
    ds_read_b128 v[72:75], v14 offset:4096
    ds_read_b128 v[76:79], v15 offset:4096
L_w33:
    s_sub_u32 s67, s67, 1
    s_cbranch_scc1 L_abort
    ds_read_b32 v8, v2 offset:7184
    s_waitcnt lgkmcnt(0)
    v_cmp_le_i32 vcc, 4, v8
    s_cbranch_vccz L_w33
    ds_read_b128 v[32:35], v16 offset:2304
    ds_read_b128 v[36:39], v16 offset:2368
    ds_read_b128 v[40:43], v16 offset:2432
    ds_read_b128 v[44:47], v16 offset:2496
    s_waitcnt lgkmcnt(3)
    v_mfma_f32_16x16x32_bf16 v[80:83], v[48:51], v[32:35], 0
    v_mfma_f32_16x16x32_bf16 v[84:87], v[64:67], v[32:35], 0
    s_waitcnt lgkmcnt(2)
    v_mfma_f32_16x16x32_bf16 v[80:83], v[52:55], v[36:39], v[80:83]
    v_mfma_f32_16x16x32_bf16 v[84:87], v[68:71], v[36:39], v[84:87]
    s_waitcnt lgkmcnt(1)
    v_mfma_f32_16x16x32_bf16 v[80:83], v[56:59], v[40:43], v[80:83]
    v_mfma_f32_16x16x32_bf16 v[84:87], v[72:75], v[40:43], v[84:87]
    s_waitcnt lgkmcnt(0)
    v_mfma_f32_16x16x32_bf16 v[80:83], v[60:63], v[44:47], v[80:83]
    v_mfma_f32_16x16x32_bf16 v[84:87], v[76:79], v[44:47], v[84:87]
    s_nop 6
    v_cvt_pk_bf16_f32 v80, 0, v80
    v_cvt_pk_bf16_f32 v81, 0, v81
    v_cvt_pk_bf16_f32 v82, 0, v82
    v_cvt_pk_bf16_f32 v83, 0, v83
    v_cvt_pk_bf16_f32 v84, 0, v84
    v_cvt_pk_bf16_f32 v85, 0, v85
    v_cvt_pk_bf16_f32 v86, 0, v86
    v_cvt_pk_bf16_f32 v87, 0, v87
    v_mul_f32 v80, 0x3db504f3, v80
    v_mul_f32 v81, 0x3db504f3, v81
    v_mul_f32 v82, 0x3db504f3, v82
    v_mul_f32 v83, 0x3db504f3, v83
    v_mul_f32 v84, 0x3db504f3, v84
    v_mul_f32 v85, 0x3db504f3, v85
    v_mul_f32 v86, 0x3db504f3, v86
    v_mul_f32 v87, 0x3db504f3, v87
    v_cvt_pk_bf16_f32 v80, 0, v80
    v_cvt_pk_bf16_f32 v81, 0, v81
    v_cvt_pk_bf16_f32 v82, 0, v82
    v_cvt_pk_bf16_f32 v83, 0, v83
    v_cvt_pk_bf16_f32 v84, 0, v84
    v_cvt_pk_bf16_f32 v85, 0, v85
    v_cvt_pk_bf16_f32 v86, 0, v86
    v_cvt_pk_bf16_f32 v87, 0, v87
    v_max3_f32 v32, v80, v81, v82
    v_max3_f32 v33, v83, v84, v85
    v_max3_f32 v32, v32, v86, v87
    v_max_f32 v32, v32, v33
    v_mov_b32 v33, v32
    s_nop 1
    v_permlane16_swap_b32 v32, v33
    v_max_f32 v32, v32, v33
    v_mov_b32 v33, v32
    s_nop 1
    v_permlane32_swap_b32 v32, v33
    v_max_f32 v32, v32, v33
    s_mov_b64 exec, 4369
    ds_write_b32 v17, v32 offset:5888
    s_mov_b64 exec, 1
    ds_add_u32 v2, v5 offset:7188
    s_mov_b64 exec, -1
    s_mov_b32 s34, 0x3fb8aa3b
L_w34:
    s_sub_u32 s67, s67, 1
    s_cbranch_scc1 L_abort
    ds_read_b32 v8, v2 offset:7188
    s_waitcnt lgkmcnt(0)
    v_cmp_le_i32 vcc, 8, v8
    s_cbranch_vccz L_w34
    ds_read_b128 v[32:35], v18 offset:5888
    ds_read_b128 v[36:39], v18 offset:5904
    s_waitcnt lgkmcnt(0)
    v_max3_f32 v32, v32, v33, v34
    v_max3_f32 v35, v35, v36, v37
    v_max3_f32 v32, v32, v38, v39
    v_max_f32 v8, v32, v35
    v_sub_f32 v80, v80, v8
    v_sub_f32 v81, v81, v8
    v_sub_f32 v82, v82, v8
    v_sub_f32 v83, v83, v8
    v_sub_f32 v84, v84, v8
    v_sub_f32 v85, v85, v8
    v_sub_f32 v86, v86, v8
    v_sub_f32 v87, v87, v8
    v_mul_f32 v80, s34, v80
    v_mul_f32 v81, s34, v81
    v_mul_f32 v82, s34, v82
    v_mul_f32 v83, s34, v83
    v_mul_f32 v84, s34, v84
    v_mul_f32 v85, s34, v85
    v_mul_f32 v86, s34, v86
    v_mul_f32 v87, s34, v87
    v_exp_f32 v80, v80
    v_exp_f32 v81, v81
    v_exp_f32 v82, v82
    v_exp_f32 v83, v83
    v_exp_f32 v84, v84
    v_exp_f32 v85, v85
    v_exp_f32 v86, v86
    v_exp_f32 v87, v87
    v_cvt_pk_bf16_f32 v32, v80, v81
    v_cvt_pk_bf16_f32 v33, v82, v83
    v_cvt_pk_bf16_f32 v34, v84, v85
    v_cvt_pk_bf16_f32 v35, v86, v87
    s_mov_b32 exec_lo, 0x11111111
    s_mov_b32 exec_hi, 0x11111111
    ds_write_b128 v19, v[32:35] offset:3584
    s_mov_b64 exec, -1
    v_add_f32 v80, v80, v84
    v_add_f32 v81, v81, v85
    v_add_f32 v82, v82, v86
    v_add_f32 v83, v83, v87
    v_add_f32 v80, v80, v81
    v_add_f32 v82, v82, v83
    v_add_f32 v80, v80, v82
    v_mov_b32 v81, v80
    s_nop 1
    v_permlane16_swap_b32 v80, v81
    v_add_f32 v80, v80, v81
    v_mov_b32 v81, v80
    s_nop 1
    v_permlane32_swap_b32 v80, v81
    v_add_f32 v80, v80, v81
    s_mov_b64 exec, 4369
    ds_write_b32 v17, v80 offset:6016
    s_mov_b64 exec, 1
    ds_add_u32 v2, v5 offset:7192
    s_mov_b64 exec, -1
    s_cmp_ge_u32 s70, 4
    s_cbranch_scc1 L_comb
    s_setprio 2
L_w35:
    s_sub_u32 s67, s67, 1
    s_cbranch_scc1 L_abort
    ds_read_b32 v9, v2 offset:7192
    s_waitcnt lgkmcnt(0)
    v_cmp_le_i32 vcc, 8, v9
    s_cbranch_vccz L_w35
    ds_read_b128 v[32:35], v20 offset:3584
    ds_read_b128 v[36:39], v20 offset:3648
    ds_read_b128 v[40:43], v20 offset:3712
    ds_read_b128 v[44:47], v20 offset:3776
    ds_read_b128 v[48:51], v20 offset:3840
    ds_read_b128 v[52:55], v20 offset:3904
    ds_read_b128 v[56:59], v20 offset:3968
    ds_read_b128 v[60:63], v20 offset:4032
    s_cmp_lg_u32 s70, 0
    s_cbranch_scc1 L_noml
    ds_read_b128 v[64:67], v18 offset:6016
    ds_read_b128 v[68:71], v18 offset:6032
    v_lshlrev_b32 v72, 9, v7
    s_waitcnt lgkmcnt(0)
    v_add_f32 v64, v64, v68
    v_add_f32 v65, v65, v69
    v_add_f32 v66, v66, v70
    v_add_f32 v67, v67, v71
    v_add_f32 v64, v64, v65
    v_add_f32 v66, v66, v67
    v_add_f32 v65, v64, v66
    v_bfi_b32 v64, s65, v3, v8
    v_bfi_b32 v65, s65, v3, v65
    v_mov_b32 v66, v64
    v_mov_b32 v67, v65
    s_mov_b64 exec, 4369
    s_cmp_eq_u32 s64, 2
    s_cbranch_scc0 L_far36
    buffer_store_dwordx4 v[64:67], v72, s[40:43], s77 offen
L_pub37:
    s_mov_b64 exec, -1
L_noml:
    v_xor_b32 v24, 32, v21
    v_xor_b32 v25, 32, v22
    v_and_b32 v28, 1, v0
    v_mul_u32_u24 v29, 320, v28
    v_add3_u32 v29, v29, v6, v2
    v_lshl_add_u32 v28, v28, 6, v6
    s_add_u32 s33, s29, 3
    s_and_b32 s33, s33, 7
    s_lshl_b32 s33, s33, 2
    s_add_u32 s33, s33, s70
    s_lshl_b32 s33, s33, 13
    s_lshl_b32 s34, s28, 2
    s_lshr_b32 s72, s29, 3
    s_add_u32 s34, s34, s72
    s_lshl_b32 s34, s34, 7
    s_add_u32 s33, s33, s34
    s_add_u32 s72, s33, 921600
L_w38:
    s_sub_u32 s67, s67, 1
    s_cbranch_scc1 L_abort
    ds_read_b32 v9, v2 offset:7168
    s_waitcnt lgkmcnt(0)
    v_cmp_le_i32 vcc, 120, v9
    s_cbranch_vccz L_w38
    ds_read_b64_tr_b16 v[64:65], v21 offset:0
    ds_read_b64_tr_b16 v[66:67], v21 offset:4096
    ds_read_b64_tr_b16 v[68:69], v24 offset:0
    ds_read_b64_tr_b16 v[70:71], v24 offset:4096
    ds_read_b64_tr_b16 v[72:73], v21 offset:8192
    ds_read_b64_tr_b16 v[74:75], v21 offset:12288
    ds_read_b64_tr_b16 v[76:77], v24 offset:8192
    ds_read_b64_tr_b16 v[78:79], v24 offset:12288
    ds_read_b64_tr_b16 v[80:81], v21 offset:16384
    ds_read_b64_tr_b16 v[82:83], v21 offset:20480
    ds_read_b64_tr_b16 v[84:85], v24 offset:16384
    ds_read_b64_tr_b16 v[86:87], v24 offset:20480
    s_waitcnt lgkmcnt(10)
    v_mfma_f32_16x16x32_bf16 v[96:99], v[64:67], v[32:35], 0
    s_waitcnt lgkmcnt(8)
    v_mfma_f32_16x16x32_bf16 v[100:103], v[68:71], v[32:35], 0
    s_waitcnt lgkmcnt(6)
    v_mfma_f32_16x16x32_bf16 v[96:99], v[72:75], v[36:39], v[96:99]
    s_waitcnt lgkmcnt(4)
    v_mfma_f32_16x16x32_bf16 v[100:103], v[76:79], v[36:39], v[100:103]
    s_waitcnt lgkmcnt(2)
    v_mfma_f32_16x16x32_bf16 v[96:99], v[80:83], v[40:43], v[96:99]
    s_waitcnt lgkmcnt(0)
    v_mfma_f32_16x16x32_bf16 v[100:103], v[84:87], v[40:43], v[100:103]
L_w39:
    s_sub_u32 s67, s67, 1
    s_cbranch_scc1 L_abort
    ds_read_b32 v9, v2 offset:7168
    s_waitcnt lgkmcnt(0)
    v_cmp_le_i32 vcc, 128, v9
    s_cbranch_vccz L_w39
    ds_read_b64_tr_b16 v[64:65], v21 offset:24576
    ds_read_b64_tr_b16 v[66:67], v21 offset:28672
    ds_read_b64_tr_b16 v[68:69], v24 offset:24576
    ds_read_b64_tr_b16 v[70:71], v24 offset:28672
    s_waitcnt lgkmcnt(2)
    v_mfma_f32_16x16x32_bf16 v[96:99], v[64:67], v[44:47], v[96:99]
    s_waitcnt lgkmcnt(0)
    v_mfma_f32_16x16x32_bf16 v[100:103], v[68:71], v[44:47], v[100:103]
L_w40:
    s_sub_u32 s67, s67, 1
    s_cbranch_scc1 L_abort
    ds_read_b32 v9, v2 offset:7168
    s_waitcnt lgkmcnt(0)
    v_cmp_le_i32 vcc, 136, v9
    s_cbranch_vccz L_w40
    ds_read_b64_tr_b16 v[64:65], v21 offset:32768
    ds_read_b64_tr_b16 v[66:67], v21 offset:36864
    ds_read_b64_tr_b16 v[68:69], v24 offset:32768
    ds_read_b64_tr_b16 v[70:71], v24 offset:36864
    s_waitcnt lgkmcnt(2)
    v_mfma_f32_16x16x32_bf16 v[96:99], v[64:67], v[48:51], v[96:99]
    s_waitcnt lgkmcnt(0)
    v_mfma_f32_16x16x32_bf16 v[100:103], v[68:71], v[48:51], v[100:103]
L_w41:
    s_sub_u32 s67, s67, 1
    s_cbranch_scc1 L_abort
    ds_read_b32 v9, v2 offset:7168
    s_waitcnt lgkmcnt(0)
    v_cmp_le_i32 vcc, 144, v9
    s_cbranch_vccz L_w41
    ds_read_b64_tr_b16 v[64:65], v21 offset:40960
    ds_read_b64_tr_b16 v[66:67], v21 offset:45056
    ds_read_b64_tr_b16 v[68:69], v24 offset:40960
    ds_read_b64_tr_b16 v[70:71], v24 offset:45056
    s_waitcnt lgkmcnt(2)
    v_mfma_f32_16x16x32_bf16 v[96:99], v[64:67], v[52:55], v[96:99]
    s_waitcnt lgkmcnt(0)
    v_mfma_f32_16x16x32_bf16 v[100:103], v[68:71], v[52:55], v[100:103]
    s_mov_b32 exec_lo, 0x33333333
    s_mov_b32 exec_hi, 0x33333333
    buffer_load_dwordx4 v[88:91], v23, s[40:43], s71 offen sc1 nt
    s_mov_b64 exec, -1
L_w42:
    s_sub_u32 s67, s67, 1
    s_cbranch_scc1 L_abort
    ds_read_b32 v9, v2 offset:7168
    s_waitcnt lgkmcnt(0)
    v_cmp_le_i32 vcc, 152, v9
    s_cbranch_vccz L_w42
    ds_read_b64_tr_b16 v[64:65], v21 offset:49152
    ds_read_b64_tr_b16 v[66:67], v21 offset:53248
    ds_read_b64_tr_b16 v[68:69], v24 offset:49152
    ds_read_b64_tr_b16 v[70:71], v24 offset:53248
    s_waitcnt lgkmcnt(2)
    v_mfma_f32_16x16x32_bf16 v[96:99], v[64:67], v[56:59], v[96:99]
    s_waitcnt lgkmcnt(0)
    v_mfma_f32_16x16x32_bf16 v[100:103], v[68:71], v[56:59], v[100:103]
    s_mov_b32 s34, 0x22222222
    s_mov_b32 s35, 0x22222222
L_w43:
    s_sub_u32 s67, s67, 1
    s_cbranch_scc1 L_abort
    ds_read_b32 v9, v2 offset:7168
    s_waitcnt lgkmcnt(0)
    v_cmp_le_i32 vcc, 160, v9
    s_cbranch_vccz L_w43
    ds_read_b64_tr_b16 v[64:65], v22 offset:0
    ds_read_b64_tr_b16 v[66:67], v22 offset:4096
    ds_read_b64_tr_b16 v[68:69], v25 offset:0
    ds_read_b64_tr_b16 v[70:71], v25 offset:4096
    s_waitcnt lgkmcnt(2)
    v_mfma_f32_16x16x32_bf16 v[96:99], v[64:67], v[60:63], v[96:99]
    s_waitcnt lgkmcnt(0)
    v_mfma_f32_16x16x32_bf16 v[100:103], v[68:71], v[60:63], v[100:103]
    s_mov_b32 exec_lo, 0x33333333
    s_mov_b32 exec_hi, 0x33333333
    s_cmp_eq_u32 s64, 2
    s_nop 4
    v_cndmask_b32 v96, v96, v100, s[34:35]
    v_cndmask_b32 v97, v97, v101, s[34:35]
    v_cndmask_b32 v98, v98, v102, s[34:35]
    v_cndmask_b32 v99, v99, v103, s[34:35]
    v_bfi_b32 v96, s65, v3, v96
    v_bfi_b32 v97, s65, v3, v97
    v_bfi_b32 v98, s65, v3, v98
    v_bfi_b32 v99, s65, v3, v99
    s_cbranch_scc0 L_far44
    buffer_store_dwordx4 v[96:99], v23, s[40:43], s71 offen
L_pub45:
    s_mov_b64 exec, -1
L_w46:
    s_sub_u32 s67, s67, 1
    s_cbranch_scc1 L_abort
    ds_read_b32 v9, v2 offset:7168
    s_waitcnt lgkmcnt(0)
    v_cmp_le_i32 vcc, 184, v9
    s_cbranch_vccz L_w46
    ds_read_b64_tr_b16 v[48:49], v11 offset:0
    ds_read_b64_tr_b16 v[50:51], v11 offset:2048
    ds_read_b64_tr_b16 v[52:53], v11 offset:4096
    ds_read_b64_tr_b16 v[54:55], v11 offset:6144
    ds_read_b64_tr_b16 v[56:57], v11 offset:8192
    ds_read_b64_tr_b16 v[58:59], v11 offset:10240
    ds_read_b64_tr_b16 v[60:61], v11 offset:12288
    ds_read_b64_tr_b16 v[62:63], v11 offset:14336
    s_waitcnt lgkmcnt(0)
    s_barrier
    ds_read_b128 v[32:35], v29 offset:6144
    ds_read_b128 v[36:39], v29 offset:6208
    ds_read_b128 v[40:43], v29 offset:6272
    ds_read_b128 v[44:47], v29 offset:6336
    s_waitcnt lgkmcnt(3)
    v_mfma_f32_16x16x32_bf16 v[80:83], v[48:51], v[32:35], 0
    s_waitcnt lgkmcnt(2)
    v_mfma_f32_16x16x32_bf16 v[80:83], v[52:55], v[36:39], v[80:83]
    s_waitcnt lgkmcnt(1)
    v_mfma_f32_16x16x32_bf16 v[80:83], v[56:59], v[40:43], v[80:83]
    s_waitcnt lgkmcnt(0)
    v_mfma_f32_16x16x32_bf16 v[80:83], v[60:63], v[44:47], v[80:83]
    s_mov_b32 exec_lo, 0x30003
    s_mov_b32 exec_hi, 0x30003
    s_nop 5
    v_bfi_b32 v80, s65, v3, v80
    v_bfi_b32 v81, s65, v3, v81
    v_bfi_b32 v82, s65, v3, v82
    v_bfi_b32 v83, s65, v3, v83
    buffer_store_dwordx4 v[80:83], v28, s[40:43], s72 offen sc1
    s_waitcnt vmcnt(0)
    s_barrier
L_cend:
    s_endpgm
L_comb:
    s_setprio 1
    s_and_b32 s72, s70, 1
    s_bfe_u32 s75, s70, 0x10001
    s_lshr_b32 s74, s29, 3
    s_lshl_b32 s33, s28, 11
    s_lshl_b32 s34, s74, 9
    s_add_u32 s33, s33, s34
    s_lshl_b32 s34, s72, 8
    s_add_u32 s33, s33, s34
    s_add_u32 s77, s33, 364544
    v_lshlrev_b32 v24, 2, v6
    v_and_b32 v26, 15, v0
    v_lshlrev_b32 v25, 7, v6
    v_lshl_add_u32 v25, v26, 4, v25
    s_lshl_b32 s33, s28, 16
    s_lshl_b32 s34, s74, 14
    s_add_u32 s33, s33, s34
    s_lshl_b32 s34, s72, 13
    s_add_u32 s33, s33, s34
    s_lshl_b32 s34, s75, 8
    s_add_u32 s33, s33, s34
    s_add_u32 s73, s33, 397312
    v_and_b32 v26, 3, v0
    v_lshlrev_b32 v26, 4, v26
    v_bfe_u32 v27, v0, 2, 1
    v_lshl_add_u32 v26, v27, 3, v26
    v_bfe_u32 v27, v0, 3, 1
    v_lshl_add_u32 v26, v27, 6, v26
    v_bfe_u32 v27, v0, 4, 1
    v_lshl_add_u32 v26, v27, 2, v26
    v_lshrrev_b32 v27, 5, v0
    v_lshl_add_u32 v26, v27, 1, v26
    s_mul_i32 s33, s72, 320
    s_lshl_b32 s34, s75, 7
    s_add_u32 s33, s33, s34
    s_add_u32 s33, s33, 161792
    v_add_u32 v26, s33, v26
    s_mov_b32 s34, 0x3fb8aa3b
L_w47:
    s_sub_u32 s67, s67, 1
    s_cbranch_scc1 L_abort
    ds_read_b32 v9, v2 offset:7168
    s_waitcnt lgkmcnt(0)
    v_cmp_le_i32 vcc, 140, v9
    s_cbranch_vccz L_w47
L_pa48:
    s_sub_u32 s67, s67, 16
    s_cbranch_scc1 L_abort
    ds_read_b32 v9, v2 offset:7168
    buffer_load_dwordx4 v[64:67], v24, s[40:43], s77 offen offset:0 sc1
    buffer_load_dwordx4 v[68:71], v24, s[40:43], s77 offen offset:16 sc1
    buffer_load_dwordx4 v[72:75], v24, s[40:43], s77 offen offset:32 sc1
    buffer_load_dwordx4 v[76:79], v24, s[40:43], s77 offen offset:48 sc1
    s_waitcnt lgkmcnt(0)
    v_cmp_le_i32 vcc, 160, v9
    s_nop 0
    s_mov_b64 s[74:75], vcc
    s_cmp_eq_u64 s[74:75], 0
    s_cbranch_scc1 L_pm49
    buffer_load_dwordx4 v[32:35], v25, s[40:43], s73 offen offset:0 sc1
    buffer_load_dwordx4 v[36:39], v25, s[40:43], s73 offen offset:512 sc1
    buffer_load_dwordx4 v[40:43], v25, s[40:43], s73 offen offset:1024 sc1
    buffer_load_dwordx4 v[44:47], v25, s[40:43], s73 offen offset:1536 sc1
L_pm49:
    s_waitcnt vmcnt(0)
    v_bitop3_b32 v48, v64, v65, v3 bitop3:0x7e
    v_bitop3_b32 v49, v66, v67, v3 bitop3:0x7e
    v_bitop3_b32 v50, v68, v69, v3 bitop3:0x7e
    v_bitop3_b32 v51, v70, v71, v3 bitop3:0x7e
    v_bitop3_b32 v52, v72, v73, v3 bitop3:0x7e
    v_bitop3_b32 v53, v74, v75, v3 bitop3:0x7e
    v_bitop3_b32 v54, v76, v77, v3 bitop3:0x7e
    v_bitop3_b32 v55, v78, v79, v3 bitop3:0x7e
    v_or3_b32 v48, v48, v49, v50
    v_or3_b32 v51, v51, v52, v53
    v_or_b32 v54, v54, v55
    v_or3_b32 v48, v48, v51, v54
    v_and_b32 v48, s65, v48
    v_cmp_ne_u32 vcc, 0, v48
    s_cbranch_vccnz L_pa48
    v_xor_b32 v80, v3, v64
    v_xor_b32 v82, v3, v68
    v_xor_b32 v84, v3, v72
    v_xor_b32 v86, v3, v76
    v_max3_f32 v8, v80, v82, v84
    v_max_f32 v8, v8, v86
    v_mov_b32 v9, v8
    s_nop 1
    v_permlane16_swap_b32 v8, v9
    v_max_f32 v8, v8, v9
    v_mov_b32 v9, v8
    s_nop 1
    v_permlane32_swap_b32 v8, v9
    v_max_f32 v8, v8, v9
    v_sub_f32 v80, v80, v8
    v_sub_f32 v82, v82, v8
    v_sub_f32 v84, v84, v8
    v_sub_f32 v86, v86, v8
    v_mul_f32 v80, s34, v80
    v_mul_f32 v82, s34, v82
    v_mul_f32 v84, s34, v84
    v_mul_f32 v86, s34, v86
    v_exp_f32 v80, v80
    v_exp_f32 v82, v82
    v_exp_f32 v84, v84
    v_exp_f32 v86, v86
    v_mul_f32 v8, v80, v65
    v_fmac_f32 v8, v82, v69
    v_fmac_f32 v8, v84, v73
    v_fmac_f32 v8, v86, v77
    v_mov_b32 v9, v8
    s_nop 1
    v_permlane16_swap_b32 v8, v9
    v_add_f32 v8, v8, v9
    v_mov_b32 v9, v8
    s_nop 1
    v_permlane32_swap_b32 v8, v9
    v_add_f32 v8, v8, v9
    v_rcp_f32 v8, v8
    s_nop 0
    v_mul_f32 v80, v80, v8
    v_mul_f32 v82, v82, v8
    v_mul_f32 v84, v84, v8
    v_mul_f32 v86, v86, v8
    s_cmp_lg_u64 s[74:75], 0
    s_cbranch_scc1 L_pc51
L_w52:
    s_sub_u32 s67, s67, 1
    s_cbranch_scc1 L_abort
    ds_read_b32 v9, v2 offset:7168
    s_waitcnt lgkmcnt(0)
    v_cmp_le_i32 vcc, 160, v9
    s_cbranch_vccz L_w52
    s_branch L_pf53
L_pb50:
L_pf53:
    s_sub_u32 s67, s67, 16
    s_cbranch_scc1 L_abort
    buffer_load_dwordx4 v[32:35], v25, s[40:43], s73 offen offset:0 sc1
    buffer_load_dwordx4 v[36:39], v25, s[40:43], s73 offen offset:512 sc1
    buffer_load_dwordx4 v[40:43], v25, s[40:43], s73 offen offset:1024 sc1
    buffer_load_dwordx4 v[44:47], v25, s[40:43], s73 offen offset:1536 sc1
    s_waitcnt vmcnt(0)
L_pc51:
    v_bitop3_b32 v48, v32, v33, v3 bitop3:0x7e
    v_bitop3_b32 v49, v34, v35, v3 bitop3:0x7e
    v_bitop3_b32 v50, v36, v37, v3 bitop3:0x7e
    v_bitop3_b32 v51, v38, v39, v3 bitop3:0x7e
    v_bitop3_b32 v52, v40, v41, v3 bitop3:0x7e
    v_bitop3_b32 v53, v42, v43, v3 bitop3:0x7e
    v_bitop3_b32 v54, v44, v45, v3 bitop3:0x7e
    v_bitop3_b32 v55, v46, v47, v3 bitop3:0x7e
    v_or3_b32 v48, v48, v49, v50
    v_pk_mul_f32 v[32:33], v[32:33], v[80:81] op_sel_hi:[1,0]
    v_pk_mul_f32 v[34:35], v[34:35], v[80:81] op_sel_hi:[1,0]
    v_or3_b32 v51, v51, v52, v53
    v_pk_fma_f32 v[32:33], v[36:37], v[82:83], v[32:33] op_sel_hi:[1,0,1]
    v_pk_fma_f32 v[34:35], v[38:39], v[82:83], v[34:35] op_sel_hi:[1,0,1]
    v_or_b32 v54, v54, v55
    v_pk_fma_f32 v[32:33], v[40:41], v[84:85], v[32:33] op_sel_hi:[1,0,1]
    v_pk_fma_f32 v[34:35], v[42:43], v[84:85], v[34:35] op_sel_hi:[1,0,1]
    v_or3_b32 v48, v48, v51, v54
    v_pk_fma_f32 v[32:33], v[44:45], v[86:87], v[32:33] op_sel_hi:[1,0,1]
    v_pk_fma_f32 v[34:35], v[46:47], v[86:87], v[34:35] op_sel_hi:[1,0,1]
    v_and_b32 v48, s65, v48
    v_cmp_ne_u32 vcc, 0, v48
    s_cbranch_vccnz L_pb50
    v_permlane32_swap_b32 v32, v33
    v_permlane32_swap_b32 v34, v35
    v_add_f32 v32, v32, v33
    v_add_f32 v34, v34, v35
    s_nop 1
    v_permlane16_swap_b32 v32, v34
    v_add_f32 v32, v32, v34
    v_cvt_pk_bf16_f32 v32, v32, v32
    ds_write_b16 v26, v32
    s_waitcnt lgkmcnt(0)
    s_barrier
    s_endpgm
L_far26:
    buffer_store_dwordx4 v[64:67], v26, s[40:43], s72 offen sc1
    s_branch L_pub27
L_far36:
    buffer_store_dwordx4 v[64:67], v72, s[40:43], s77 offen sc1
    s_branch L_pub37
L_far44:
    buffer_store_dwordx4 v[96:99], v23, s[40:43], s71 offen sc1
    s_branch L_pub45
L_abort:
L_end:
    s_endpgm
L_codeend:
.section .rodata,"a"
.p2align 6
.amdhsa_kernel recurrent_scan__sliding_block_cached__glu_gated_glu__decode_kernel
  .amdhsa_next_free_vgpr 104
  .amdhsa_next_free_sgpr 102
  .amdhsa_accum_offset 104
  .amdhsa_group_segment_fixed_size 0
  .amdhsa_kernarg_size 96
  .amdhsa_user_sgpr_count 2
  .amdhsa_user_sgpr_kernarg_segment_ptr 1
  .amdhsa_system_sgpr_workgroup_id_x 1
.end_amdhsa_kernel
```
